```python
import torch

def _softmax(x, axis=-1):
    return torch.softmax(x, dim=axis)
def _gelu(x):
    return torch.nn.functional.gelu(x, approximate="tanh")
def _silu(x):
    return torch.nn.functional.silu(x)
def _sigmoid(x):
    return torch.sigmoid(x)
def _layernorm(x, axis=-1, eps=1e-5):
    m = x.mean(dim=axis, keepdim=True)
    v = x.var(dim=axis, keepdim=True, unbiased=False)
    return (x - m) / torch.sqrt(v + eps)
def _scatter_add(tgt, idx, src, axis=0):
    return tgt.clone().index_add_(axis, idx, src)
def _segment_sum(src, seg, n):
    out = torch.zeros((n,) + src.shape[1:], dtype=src.dtype)
    return out.index_add_(0, seg, src)
def _pad(x, pw):
    flat = tuple(v for pair in reversed(pw) for v in pair)
    return torch.nn.functional.pad(x, flat)

kernel_name = 'sequential_preLN__linear_attn_block__swiglu_ffn__prompt'

def setup_inputs():

    _w = (lambda a: (lambda t: t.to(torch.bfloat16) if t.is_floating_point() else t)(torch.as_tensor(a)))
    def _A_setup():
        B, S, D = 1, 2048, 512
        return {
            "x": _w((lambda *s: torch.randn(*s, dtype=torch.bfloat16) * 0.05)(B, S, D)),
            "wqkv": _w((lambda *s: torch.randn(*s, dtype=torch.bfloat16) * 0.05)(D, 3 * D)),
            "wo": _w((lambda *s: torch.randn(*s, dtype=torch.bfloat16) * 0.05)(D, D)),
        }
    _A_in = _A_setup()

    def _B_setup():
        B, S, D, F = 1, 2048, 512, 1376
        return {
            "x": _w((lambda *s: torch.randn(*s, dtype=torch.bfloat16) * 0.05)(B, S, D)),
            "w_gate": _w((lambda *s: torch.randn(*s, dtype=torch.bfloat16) * 0.05)(D, F)),
            "w_up": _w((lambda *s: torch.randn(*s, dtype=torch.bfloat16) * 0.05)(D, F)),
            "w_down": _w((lambda *s: torch.randn(*s, dtype=torch.bfloat16) * 0.05)(F, D)),
        }
    _B_in = _B_setup()

    return {
        "A_x": _A_in["x"],
        "A_wqkv": _A_in["wqkv"],
        "A_wo": _A_in["wo"],
        "B_x": _B_in["x"],
        "B_w_gate": _B_in["w_gate"],
        "B_w_up": _B_in["w_up"],
        "B_w_down": _B_in["w_down"],
    }

def reference(A_x, A_wqkv, A_wo, B_x, B_w_gate, B_w_up, B_w_down):
    def _A_ref(x, wqkv, wo):
        B, S, D = x.shape
        H = 32; Dh = D // H
        qkv = (lambda x, *d: x.permute(*d))((x @ wqkv).reshape(B, S, 3, H, Dh), 2, 0, 3, 1, 4)
        q, k, v = qkv[0], qkv[1], qkv[2]
        phi = lambda t: torch.where(t > 0, t + 1, torch.exp(t)) + 1e-6
        pq, pk = phi(q), phi(k)
        kv = torch.einsum("bhsd,bhse->bhde", pk, v)
        z = torch.einsum("bhsd->bhd", pk)
        num = torch.einsum("bhqd,bhde->bhqe", pq, kv)
        den = torch.einsum("bhqd,bhd->bhq", pq, z)[..., None] + 1e-6
        o = num / den
        return (lambda x, *d: x.permute(*d))(o, 0, 2, 1, 3).reshape(B, S, D) @ wo

    def _B_ref(x, w_gate, w_up, w_down):
        g = _silu(x @ w_gate)
        u = x @ w_up
        return (g * u) @ w_down

    x = A_x
    h = x + _A_ref(_layernorm(x, axis=-1), A_wqkv, A_wo)
    h2 = h + _B_ref(_layernorm(h, axis=-1), B_w_gate, B_w_up, B_w_down)
    return h2
```

```asm
; @launch grid=(256,1,1) block=(256,1,1) lds=163840
.amdgcn_target "amdgcn-amd-amdhsa--gfx950"
.text
.globl sequential_preLN__linear_attn_block__swiglu_ffn__prompt_kernel
.p2align 12
.p2align 8
.type sequential_preLN__linear_attn_block__swiglu_ffn__prompt_kernel,@function
sequential_preLN__linear_attn_block__swiglu_ffn__prompt_kernel:
    s_load_dwordx2 s[24:25], s[0:1], 0
    s_load_dwordx2 s[28:29], s[0:1], 8
    s_load_dwordx4 s[20:23], s[0:1], 64
    s_cmp_ge_u32 s2, 256
    s_cbranch_scc1 L_end
    v_and_b32 v10, 63, v0
    v_lshrrev_b32 v13, 6, v0
    v_lshlrev_b32 v1, 4, v10
    v_readfirstlane_b32 s52, v13
    s_getpc_b64 s[56:57]
L_pc:
    s_lshr_b32 s59, s2, 3
    s_lshl_b32 s58, s59, 10
    v_lshl_add_u32 v20, v0, 2, s58
    v_min_u32 v20, L_end-L_pc, v20
    v_mov_b32 v21, s57
    v_add_co_u32 v20, vcc, s56, v20
    s_nop 1
    v_addc_co_u32 v21, vcc, 0, v21, vcc
    global_load_dword v22, v[20:21], off
    s_bfe_u32 s53, s2, 0x20001
    s_lshr_b32 s56, s59, 2
    s_lshl3_add_u32 s53, s53, s56
    s_and_b32 s54, s2, 1
    s_and_b32 s57, s59, 3
    s_lshl2_add_u32 s54, s54, s57
    s_lshl_b32 s57, s57, 1
    s_xor_b32 s55, s56, s57
    s_lshl_b32 s60, s52, 11
    s_lshl_b32 s14, s55, 7
    s_mul_i32 s64, s55, 196608
    v_lshrrev_b32 v13, 3, v10
    v_lshrrev_b32 v14, 4, v10
    v_and_b32 v20, 7, v10
    v_xor_b32 v21, v20, v14
    v_lshlrev_b32 v21, 4, v21
    v_lshl_add_u32 v21, v13, 10, v21
    s_lshl_b32 s56, s53, 16
    s_lshl_b32 s57, s52, 14
    s_add_u32 s56, s56, s57
    v_add_u32 v152, s56, v21
    v_xor_b32_e64 v21, 64, v152
    v_add_u32 v153, 7168, v21
    v_and_b32 v21, 2, v13
    v_xor_b32 v21, v20, v21
    v_lshlrev_b32 v21, 4, v21
    s_lshl_b32 s57, s54, 7
    v_add_u32 v21, s57, v21
    s_lshl_b32 s56, s52, 4
    v_add_u32_e64 v23, s56, v13
    v_mul_u32_u24 v24, 3072, v23
    v_add_u32_e64 v154, v24, v21
    v_xor_b32_e64 v24, 64, v154
    v_add_u32 v155, 23552, v24
    s_mov_b32 s26, 2097152
    s_mov_b32 s27, 0x20000
    s_mov_b32 s30, 1572864
    s_mov_b32 s31, s27
    s_lshr_b32 s59, s2, 4
    s_lshl2_add_u32 s59, s59, s52
    s_cmp_eq_u32 s59, 9
    s_cbranch_scc0 L_args
    s_bfe_u32 s56, s2, 0x30001
    s_and_b32 s57, s2, 1
    s_lshl2_add_u32 s56, s56, s57
    s_lshl_b32 s56, s56, 12
    v_and_b32_e64 v25, 32, v10
    v_add_lshl_u32 v25, v25, v10, 7
    v_add_u32_e64 v25, s56, v25
    v_mov_b32_e64 v26, 0
    s_mov_b32 s15, 0x5bd1e995
    s_waitcnt lgkmcnt(0)
    s_load_dword s57, s[22:23], s56 offset:270336 glc
    s_load_dword s15, s[22:23], s56 offset:262144 glc
    global_store_dword v25, v26, s[22:23] sc1
    s_waitcnt lgkmcnt(1)
    s_mov_b32 s7, s15
L_args:
    s_waitcnt lgkmcnt(0)
    s_add_u32 m0, s60, 0
    s_xor_b32 s8, s14, 0
    buffer_load_dwordx4 v152, s[24:27], s8 offen offset:0 lds
    buffer_load_dwordx4 v153, s[24:27], s8 offen offset:1024 lds
    s_add_u32 m0, s60, 65536
    s_add_u32 s8, s64, 1024
    buffer_load_dwordx4 v154, s[28:31], s8 offen offset:0 lds
    buffer_load_dwordx4 v155, s[28:31], s8 offen offset:1024 lds
    s_add_u32 m0, s60, 8192
    s_xor_b32 s8, s14, 128
    buffer_load_dwordx4 v152, s[24:27], s8 offen offset:0 lds
    buffer_load_dwordx4 v153, s[24:27], s8 offen offset:1024 lds
    s_add_u32 m0, s60, 131072
    s_add_u32 s8, s64, 2048
    buffer_load_dwordx4 v154, s[28:31], s8 offen offset:0 lds
    buffer_load_dwordx4 v155, s[28:31], s8 offen offset:1024 lds
    s_bfe_u32 s58, s2, 0x10002
    s_cmp_lg_u32 s7, s15
    s_cselect_b32 s56, 1, 0
    s_xor_b32 s56, s56, s58
    s_lshl_b32 s56, s56, 8
    s_add_u32 s7, s56, 1
    s_and_b32 s56, s52, 2
    s_lshl_b32 s56, s56, 2
    s_load_dwordx2 s[32:33], s[0:1], 16
    s_load_dwordx2 s[36:37], s[0:1], s56 offset:32
    s_load_dwordx2 s[40:41], s[0:1], 48
    s_load_dwordx2 s[44:45], s[0:1], 56
    s_mov_b64 s[48:49], s[22:23]
    v_lshl_add_u32 v156, v23, 10, v21
    v_xor_b32 v24, 64, v156
    v_add_u32 v157, 7168, v24
    s_and_b32 s72, s53, 7
    s_lshl_b32 s72, s72, 16
    s_mov_b32 s3, 2000000
    s_mov_b32 s62, 1
    s_lshl2_add_u32 s63, s54, s52
    s_xor_b32 s65, s55, 1
    s_mul_i32 s65, s65, 196608
    s_xor_b32 s66, s55, 2
    s_mul_i32 s66, s66, 196608
    s_xor_b32 s67, s55, 3
    s_mul_i32 s67, s67, 196608
    s_xor_b32 s68, s55, 4
    s_mul_i32 s68, s68, 196608
    s_xor_b32 s69, s55, 5
    s_mul_i32 s69, s69, 196608
    s_xor_b32 s70, s55, 6
    s_mul_i32 s70, s70, 196608
    s_xor_b32 s71, s55, 7
    s_mul_i32 s71, s71, 196608
    v_lshlrev_b32_e64 v12, 4, v14
    v_add_u32 v12, 1024, v12
    v_mov_b32_e64 v13, 0
    s_mov_b32 s34, 524288
    s_mov_b32 s35, 0x20000
    s_mov_b32 s38, 1409024
    s_mov_b32 s39, 0x20000
    s_mov_b32 s42, 1409024
    s_mov_b32 s43, 0x20000
    s_mov_b32 s46, 2097152
    s_mov_b32 s47, 0x20000
    s_mov_b32 s50, 33554432
    s_mov_b32 s51, 0x20000
    v_and_b32_e64 v27, 15, v10
    v_bfe_u32 v28, v10, 2, 2
    v_lshl_add_u32 v28, v14, 3, v28
    v_and_b32_e64 v29, 3, v10
    v_bfe_u32 v21, v10, 1, 1
    v_lshl_add_u32 v20, v21, 5, v28
    v_mul_u32_u24 v20, 192, v20
    v_lshl_add_u32 v21, v14, 1, v21
    v_xor_b32 v21, s52, v21
    v_and_b32 v21, 3, v21
    v_lshl_add_u32 v20, v21, 4, v20
    v_and_b32_e64 v21, 1, v10
    v_lshl_add_u32 v5, v21, 3, v20
    v_add_u32 v6, 0x20000, v5
    v_lshlrev_b32_e64 v20, 7, v28
    v_bfe_u32 v21, v10, 3, 2
    v_xor_b32_e64 v21, s52, v21
    v_lshl_add_u32 v20, v21, 5, v20
    v_lshl_add_u32 v7, v29, 3, v20
    v_add_u32 v8, 0x10000, v7
    v_add_u32 v9, 0x20000, v7
    v_lshrrev_b32 v20, 1, v27
    v_xor_b32 v21, v20, v14
    v_lshlrev_b32_e64 v21, 4, v21
    v_lshl_add_u32 v21, v27, 7, v21
    v_add_u32 v162, s60, v21
    v_xor_b32 v163, 64, v162
    v_xor_b32 v164, 2048, v162
    v_xor_b32 v165, 2112, v162
    v_xor_b32 v166, 4096, v162
    v_xor_b32 v167, 4160, v162
    v_xor_b32 v168, 6144, v162
    v_xor_b32 v169, 6208, v162
    v_lshrrev_b32 v21, 5, v10
    s_lshl_b32 s56, s52, 1
    v_add_u32 v21, s56, v21
    v_xor_b32 v21, v21, v20
    v_lshlrev_b32 v21, 4, v21
    v_lshl_add_u32 v21, v27, 7, v21
    v_and_b32 v20, 1, v14
    v_lshl_add_u32 v21, v20, 3, v21
    s_xor_b32 s56, s54, s55
    s_lshl_b32 s56, s56, 13
    v_add_u32 v184, s56, v21
    s_lshl_b32 s56, s52, 6
    s_add_u32 s56, s56, 90112
    v_lshl_add_u32 v175, v27, 2, s56
    v_lshl_add_u32 v171, v14, 4, s56
    v_xor_b32 v172, 64, v171
    v_xor_b32 v176, 64, v175
    v_xor_b32 v173, 128, v171
    v_xor_b32 v177, 128, v175
    v_xor_b32 v174, 192, v171
    v_xor_b32 v178, 192, v175
    v_mul_u32_u24 v20, 1152, v29
    v_add_u32 v11, v20, v12
    v_and_b32 v20, 4, v10
    v_lshl_add_u32 v185, v20, 12, v11
    s_lshl2_add_u32 s61, s53, s52
    s_lshl_b32 s61, s61, 7
    v_mov_b32 v15, 0xb5c1a2a0
    v_mov_b32_e64 v188, 1
    v_mov_b32 v120, 0x3f803f80
    v_mov_b32 v124, 0x358637bd
    v_mov_b32_e64 v96, -1
    v_mov_b32 v121, 0x3f803f80
    v_mov_b32 v125, 0x358637bd
    v_mov_b32_e64 v97, -1
    v_mov_b32 v122, 0x3f803f80
    v_mov_b32 v126, 0x358637bd
    v_mov_b32_e64 v98, -1
    v_mov_b32 v123, 0x3f803f80
    v_mov_b32 v127, 0x358637bd
    v_mov_b32_e64 v99, -1
    s_lshr_b32 s56, s53, 1
    s_lshl3_add_u32 s56, s56, s54
    s_and_b32 s57, s52, 1
    s_lshl1_add_u32 s56, s56, s57
    s_mul_i32 s56, s56, 43
    s_and_b32 s57, s53, 1
    s_mul_i32 s57, s57, 43
    v_add_lshl_u32 v191, v10, s56, 7
    v_cmp_gt_u32 vcc, s57, v10
    s_nop 1
    v_cndmask_b32_e64 v191, 2.0, v191, vcc
    s_lshl2_add_u32 s56, s2, s52
    s_mul_i32 s56, s56, 11
    v_add_lshl_u32 v0, v10, s56, 7
    s_lshr_b32 s56, s2, 3
    s_lshl2_add_u32 s56, s56, s52
    s_mul_i32 s56, s56, 11
    v_add_lshl_u32 v20, v27, s56, 10
    v_add_u32 v20, 384, v20
    v_cmp_gt_u32 vcc, 16, v10
    s_nop 1
    v_cndmask_b32 v0, v20, v0, vcc
    s_cmp_lt_u32 s54, 4
    s_cselect_b32 vcc_lo, 0x07ff0000, 0
    s_or_b32 vcc_lo, vcc_lo, 0x7ff
    s_mov_b32 vcc_hi, 0
    v_cndmask_b32 v0, 2.0, v0, vcc
    s_lshr_b32 s10, s53, 1
    s_and_b32 s56, s53, 1
    s_lshr_b32 s57, s54, 2
    s_lshl1_add_u32 s56, s57, s56
    s_and_b32 s57, s54, 3
    s_lshl2_add_u32 s11, s56, s57
    s_lshr_b32 s15, s10, 2
    s_and_b32 s15, s15, 3
    s_lshl_b32 s15, s15, 2
    s_mul_i32 s56, s11, 3
    s_lshl1_add_u32 s57, s11, 11
    s_min_u32 s56, s56, s57
    s_lshl_b32 s56, s56, 6
    s_and_b32 s57, s52, 1
    s_mul_i32 s58, s57, 44032
    s_add_u32 s56, s56, s58
    s_mul_i32 s73, s52, 3072
    s_lshr_b32 s58, s52, 1
    s_cmp_lt_u32 s11, 11
    s_cselect_b32 s57, 12, 8
    v_add_u32_e64 v20, 0, v10
    v_mul_u32_u24 v21, 21846, v20
    v_lshrrev_b32 v21, 18, v21
    v_mul_u32_u24 v23, 12, v21
    v_sub_u32 v20, v20, v23
    v_lshrrev_b32 v23, 2, v21
    v_and_or_b32 v23, v23, 2, s58
    v_xor_b32_e64 v23, v23, v20
    v_mul_u32_u24 v21, 2752, v21
    v_lshl_add_u32 v21, v23, 4, v21
    v_add_u32 v21, s56, v21
    v_cmp_gt_u32 vcc, s57, v20
    s_nop 1
    v_cndmask_b32 v2, 2.0, v21, vcc
    v_add_u32_e64 v20, 64, v10
    v_mul_u32_u24 v21, 21846, v20
    v_lshrrev_b32 v21, 18, v21
    v_mul_u32_u24 v23, 12, v21
    v_sub_u32 v20, v20, v23
    v_lshrrev_b32 v23, 2, v21
    v_and_or_b32 v23, v23, 2, s58
    v_xor_b32_e64 v23, v23, v20
    v_mul_u32_u24 v21, 2752, v21
    v_lshl_add_u32 v21, v23, 4, v21
    v_add_u32_e64 v21, s56, v21
    v_subrev_u32 v21, 1024, v21
    v_cmp_gt_u32 vcc, s57, v20
    s_nop 1
    v_cndmask_b32_e64 v3, 2.0, v21, vcc
    v_add_u32 v20, 128, v10
    v_mul_u32_u24 v21, 21846, v20
    v_lshrrev_b32 v21, 18, v21
    v_mul_u32_u24 v23, 12, v21
    v_sub_u32_e64 v20, v20, v23
    v_lshrrev_b32_e64 v23, 2, v21
    v_and_or_b32 v23, v23, 2, s58
    v_xor_b32_e64 v23, v23, v20
    v_mul_u32_u24 v21, 2752, v21
    v_lshl_add_u32 v21, v23, 4, v21
    v_add_u32 v21, s56, v21
    v_subrev_u32 v21, 2048, v21
    v_cmp_gt_u32 vcc, s57, v20
    s_nop 1
    v_cndmask_b32_e64 v4, 2.0, v21, vcc
    s_lshr_b32 s56, s63, 4
    s_lshr_b32 s58, s53, 4
    s_xor_b32 s56, s56, s58
    s_lshl_b32 s4, s56, 13
    s_add_u32 s4, s4, 16777216
    s_lshl_b32 s5, s58, 13
    s_lshr_b32 s57, s53, 2
    s_lshl3_add_u32 s57, s63, s57
    s_lshl_b32 s16, s57, 14
    s_and_b32 s57, s53, 3
    s_mul_i32 s57, s57, 1152
    s_add_u32 s16, s16, s57
    s_add_u32 s16, s16, s4
    s_lshl_b32 s18, s63, 14
    s_add_u32 s18, s18, s5
    s_add_u32 s18, s18, 524288
    s_bfe_u32 s56, s53, 0x20001
    s_lshl2_add_u32 s56, s54, s56
    s_lshr_b32 s57, s53, 3
    s_lshl2_add_u32 s58, s56, s57
    s_lshl_b32 s17, s58, 15
    s_add_u32 s17, s17, s4
    s_mul_i32 s19, s57, 1152
    s_lshl_b32 s58, s56, 14
    s_add_u32 s19, s19, s58
    s_add_u32 s19, s19, 524288
    s_and_b32 s57, s57, 1
    s_lshl1_add_u32 s58, s56, s57
    s_lshl_b32 s58, s58, 7
    s_add_u32 s6, s58, s5
    s_lshl_b32 s56, s56, 8
    s_add_u32 s56, s56, 98304
    v_and_b32_e64 v20, 2, v10
    v_lshlrev_b32_e64 v20, 12, v20
    v_and_b32_e64 v21, 1, v10
    v_lshl_add_u32 v20, v21, 7, v20
    v_add_u32 v190, s56, v20
    s_lshl1_add_u32 s9, s63, s57
    s_lshl_b32 s9, s9, 7
    s_add_u32 s9, s9, s5
    s_and_b32 s56, s53, 1
    s_cselect_b32 s56, 0, s52
    s_cmp_eq_u32 s56, 3
    s_cselect_b32 s19, s19, 0
    s_mov_b32 s12, 0xaaaaaaaa
    s_mov_b32 s13, 0xaaaaaaaa
    s_cmp_eq_u32 s59, 9
    s_cbranch_scc1 L_ini3
    s_mov_b64 exec, 0
    s_cmp_eq_u32 s52, 0
    s_cbranch_scc1 L_pad0
    s_cmp_eq_u32 s52, 1
    s_cbranch_scc1 L_pad2
    s_cmp_eq_u32 s52, 2
    s_cbranch_scc1 L_pad4
    s_branch L_pad6
L_ini3:
    s_waitcnt vmcnt(8)
    s_atomic_add s7, s[20:21], 0
L_back:
    s_mov_b64 exec, -1
    s_waitcnt vmcnt(4)
    s_barrier
    ds_read_b128 a[0:3], v162 offset:0
    ds_read_b128 a[16:19], v163 offset:0
    ds_read_b128 a[4:7], v164 offset:0
    ds_read_b128 a[20:23], v165 offset:0
    s_add_u32 m0, s60, 16384
    s_xor_b32 s8, s14, 256
    buffer_load_dwordx4 v152, s[24:27], s8 offen offset:0 lds
    ds_read_b128 a[8:11], v166 offset:0
    ds_read_b128 a[24:27], v167 offset:0
    ds_read_b128 a[12:15], v168 offset:0
    ds_read_b128 a[28:31], v169 offset:0
    ds_read_b64_tr_b16 v[64:65], v8 offset:0
    ds_read_b64_tr_b16 v[66:67], v8 offset:512
    ds_read_b64_tr_b16 v[68:69], v8 offset:4096
    ds_read_b64_tr_b16 v[70:71], v8 offset:4608
    buffer_load_dwordx4 v153, s[24:27], s8 offen offset:1024 lds
    s_waitcnt vmcnt(4)
    s_barrier
    s_waitcnt lgkmcnt(4)
    v_mfma_f32_16x16x32_bf16 v[28:31], a[0:3], a[0:3], 0
    s_nop 0
    ds_read_b128 a[32:35], v162 offset:8192
    s_add_u32 m0, s60, 73728
    s_add_u32 s8, s65, 1024
    buffer_load_dwordx4 v154, s[28:31], s8 offen offset:0 lds
    v_mfma_f32_16x16x32_bf16 v[112:115], v[120:123], a[0:3], 0
    ds_read_b128 a[48:51], v163 offset:8192
    v_mfma_f32_16x16x32_bf16 v[28:31], a[16:19], a[16:19], v[28:31]
    s_nop 0
    buffer_load_dwordx4 v155, s[28:31], s8 offen offset:1024 lds
    v_mfma_f32_16x16x32_bf16 v[112:115], v[120:123], a[16:19], v[112:115]
    s_nop 0
    ds_read_b128 a[36:39], v164 offset:8192
    s_add_u32 m0, s60, 24576
    s_xor_b32 s8, s14, 384
    buffer_load_dwordx4 v152, s[24:27], s8 offen offset:0 lds
    s_waitcnt lgkmcnt(3)
    v_mfma_f32_16x16x32_bf16 v[16:19], v[120:123], v[64:67], 0
    s_nop 0
    ds_read_b128 a[52:55], v165 offset:8192
    v_mfma_f32_16x16x32_bf16 v[32:35], a[0:3], v[64:67], 0
    buffer_load_dwordx4 v153, s[24:27], s8 offen offset:1024 lds
    v_mfma_f32_16x16x32_bf16 v[36:39], a[4:7], v[64:67], 0
    ds_read_b128 a[40:43], v166 offset:8192
    v_mfma_f32_16x16x32_bf16 v[40:43], a[8:11], v[64:67], 0
    s_add_u32 m0, s60, 32768
    s_xor_b32 s8, s14, 512
    buffer_load_dwordx4 v152, s[24:27], s8 offen offset:0 lds
    ds_read_b128 a[56:59], v167 offset:8192
    v_mfma_f32_16x16x32_bf16 v[44:47], a[12:15], v[64:67], 0
    buffer_load_dwordx4 v153, s[24:27], s8 offen offset:1024 lds
    v_mfma_f32_16x16x32_bf16 v[16:19], v[120:123], v[68:71], v[16:19]
    ds_read_b128 a[44:47], v168 offset:8192
    v_mfma_f32_16x16x32_bf16 v[32:35], a[16:19], v[68:71], v[32:35]
    s_add_u32 m0, s60, 40960
    s_xor_b32 s8, s14, 640
    buffer_load_dwordx4 v152, s[24:27], s8 offen offset:0 lds
    ds_read_b128 a[60:63], v169 offset:8192
    v_mfma_f32_16x16x32_bf16 v[36:39], a[20:23], v[68:71], v[36:39]
    buffer_load_dwordx4 v153, s[24:27], s8 offen offset:1024 lds
    v_mfma_f32_16x16x32_bf16 v[40:43], a[24:27], v[68:71], v[40:43]
    s_add_u32 m0, s60, 81920
    s_add_u32 s8, s66, 1024
    buffer_load_dwordx4 v154, s[28:31], s8 offen offset:0 lds
    v_mfma_f32_16x16x32_bf16 v[44:47], a[28:31], v[68:71], v[44:47]
    buffer_load_dwordx4 v155, s[28:31], s8 offen offset:1024 lds
    s_waitcnt vmcnt(8)
    s_barrier
    s_waitcnt lgkmcnt(0)
    v_mfma_f32_16x16x32_bf16 v[28:31], a[32:35], a[32:35], v[28:31]
    s_nop 0
    ds_read_b64_tr_b16 v[72:73], v8 offset:8192
    ds_read_b64_tr_b16 v[74:75], v8 offset:8704
    s_add_u32 m0, s60, 49152
    s_xor_b32 s8, s14, 768
    buffer_load_dwordx4 v152, s[24:27], s8 offen offset:0 lds
    ds_read_b64_tr_b16 v[76:77], v8 offset:12288
    v_mfma_f32_16x16x32_bf16 v[112:115], v[120:123], a[32:35], v[112:115]
    ds_read_b64_tr_b16 v[78:79], v8 offset:12800
    ds_read_b128 a[64:67], v162 offset:16384
    ds_read_b128 a[80:83], v163 offset:16384
    buffer_load_dwordx4 v153, s[24:27], s8 offen offset:1024 lds
    v_mfma_f32_16x16x32_bf16 v[28:31], a[48:51], a[48:51], v[28:31]
    ds_read_b128 a[68:71], v164 offset:16384
    ds_read_b128 a[84:87], v165 offset:16384
    ds_read_b128 a[72:75], v166 offset:16384
    ds_read_b128 a[88:91], v167 offset:16384
    v_mfma_f32_16x16x32_bf16 v[112:115], v[120:123], a[48:51], v[112:115]
    s_add_u32 m0, s60, 90112
    s_add_u32 s8, s67, 1024
    buffer_load_dwordx4 v154, s[28:31], s8 offen offset:0 lds
    ds_read_b128 a[76:79], v168 offset:16384
    ds_read_b128 a[92:95], v169 offset:16384
    buffer_load_dwordx4 v155, s[28:31], s8 offen offset:1024 lds
    s_waitcnt vmcnt(8)
    s_barrier
    s_waitcnt lgkmcnt(8)
    v_mfma_f32_16x16x32_bf16 v[16:19], v[120:123], v[72:75], v[16:19]
    s_nop 0
    ds_read_b128 a[96:99], v162 offset:24576
    ds_read_b128 a[112:115], v163 offset:24576
    v_mfma_f32_16x16x32_bf16 v[32:35], a[32:35], v[72:75], v[32:35]
    ds_read_b128 a[100:103], v164 offset:24576
    v_mfma_f32_16x16x32_bf16 v[36:39], a[36:39], v[72:75], v[36:39]
    s_add_u32 m0, s60, 57344
    s_xor_b32 s8, s14, 896
    buffer_load_dwordx4 v152, s[24:27], s8 offen offset:0 lds
    ds_read_b128 a[116:119], v165 offset:24576
    v_mfma_f32_16x16x32_bf16 v[40:43], a[40:43], v[72:75], v[40:43]
    ds_read_b128 a[104:107], v166 offset:24576
    v_mfma_f32_16x16x32_bf16 v[44:47], a[44:47], v[72:75], v[44:47]
    ds_read_b128 a[120:123], v167 offset:24576
    ds_read_b128 a[108:111], v168 offset:24576
    v_mfma_f32_16x16x32_bf16 v[16:19], v[120:123], v[76:79], v[16:19]
    ds_read_b128 a[124:127], v169 offset:24576
    v_mfma_f32_16x16x32_bf16 v[32:35], a[48:51], v[76:79], v[32:35]
    buffer_load_dwordx4 v153, s[24:27], s8 offen offset:1024 lds
    v_mfma_f32_16x16x32_bf16 v[36:39], a[52:55], v[76:79], v[36:39]
    ds_read_b128 a[128:131], v162 offset:32768
    ds_read_b128 a[144:147], v163 offset:32768
    v_mfma_f32_16x16x32_bf16 v[40:43], a[56:59], v[76:79], v[40:43]
    ds_read_b128 a[132:135], v164 offset:32768
    v_mfma_f32_16x16x32_bf16 v[44:47], a[60:63], v[76:79], v[44:47]
    ds_read_b128 a[148:151], v165 offset:32768
    ds_read_b128 a[136:139], v166 offset:32768
    s_waitcnt lgkmcnt(13)
    v_mfma_f32_16x16x32_bf16 v[28:31], a[64:67], a[64:67], v[28:31]
    s_nop 0
    ds_read_b128 a[152:155], v167 offset:32768
    v_mfma_f32_16x16x32_bf16 v[112:115], v[120:123], a[64:67], v[112:115]
    s_add_u32 m0, s60, 98304
    s_add_u32 s8, s68, 1024
    buffer_load_dwordx4 v154, s[28:31], s8 offen offset:0 lds
    ds_read_b128 a[140:143], v168 offset:32768
    v_mfma_f32_16x16x32_bf16 v[28:31], a[80:83], a[80:83], v[28:31]
    ds_read_b128 a[156:159], v169 offset:32768
    v_mfma_f32_16x16x32_bf16 v[112:115], v[120:123], a[80:83], v[112:115]
    buffer_load_dwordx4 v155, s[28:31], s8 offen offset:1024 lds
    s_waitcnt vmcnt(8)
    s_barrier
    s_waitcnt lgkmcnt(8)
    v_mfma_f32_16x16x32_bf16 v[28:31], a[96:99], a[96:99], v[28:31]
    s_nop 0
    ds_read_b64_tr_b16 v[80:81], v8 offset:16384
    ds_read_b64_tr_b16 v[82:83], v8 offset:16896
    v_mfma_f32_16x16x32_bf16 v[112:115], v[120:123], a[96:99], v[112:115]
    s_add_u32 m0, s60, 106496
    s_add_u32 s8, s69, 1024
    buffer_load_dwordx4 v154, s[28:31], s8 offen offset:0 lds
    ds_read_b64_tr_b16 v[84:85], v8 offset:20480
    v_mfma_f32_16x16x32_bf16 v[28:31], a[112:115], a[112:115], v[28:31]
    ds_read_b64_tr_b16 v[86:87], v8 offset:20992
    ds_read_b128 a[160:163], v162 offset:40960
    v_mfma_f32_16x16x32_bf16 v[112:115], v[120:123], a[112:115], v[112:115]
    ds_read_b128 a[176:179], v163 offset:40960
    buffer_load_dwordx4 v155, s[28:31], s8 offen offset:1024 lds
    s_waitcnt lgkmcnt(6)
    v_mfma_f32_16x16x32_bf16 v[28:31], a[128:131], a[128:131], v[28:31]
    ds_read_b128 a[164:167], v164 offset:40960
L_pad0:
    s_cbranch_execz L_pad1
    ds_read_b128 a[180:183], v165 offset:40960
    v_mfma_f32_16x16x32_bf16 v[112:115], v[120:123], a[128:131], v[112:115]
    ds_read_b128 a[168:171], v166 offset:40960
    ds_read_b128 a[184:187], v167 offset:40960
    v_mfma_f32_16x16x32_bf16 v[28:31], a[144:147], a[144:147], v[28:31]
    s_add_u32 m0, s60, 114688
    s_add_u32 s8, s70, 1024
    buffer_load_dwordx4 v154, s[28:31], s8 offen offset:0 lds
    ds_read_b128 a[172:175], v168 offset:40960
    v_mfma_f32_16x16x32_bf16 v[112:115], v[120:123], a[144:147], v[112:115]
    ds_read_b128 a[188:191], v169 offset:40960
    buffer_load_dwordx4 v155, s[28:31], s8 offen offset:1024 lds
    s_waitcnt vmcnt(8)
    s_barrier
    s_waitcnt lgkmcnt(8)
    v_mfma_f32_16x16x32_bf16 v[16:19], v[120:123], v[80:83], v[16:19]
    s_nop 0
    global_load_dword v186, v13, s[20:21] sc1
    ds_read_b64_tr_b16 v[88:89], v8 offset:24576
    ds_read_b64_tr_b16 v[90:91], v8 offset:25088
    v_mfma_f32_16x16x32_bf16 v[32:35], a[64:67], v[80:83], v[32:35]
    s_add_u32 m0, s60, 122880
    s_add_u32 s8, s71, 1024
    buffer_load_dwordx4 v154, s[28:31], s8 offen offset:0 lds
    v_mfma_f32_16x16x32_bf16 v[36:39], a[68:71], v[80:83], v[36:39]
    ds_read_b64_tr_b16 v[92:93], v8 offset:28672
    v_mfma_f32_16x16x32_bf16 v[40:43], a[72:75], v[80:83], v[40:43]
    ds_read_b64_tr_b16 v[94:95], v8 offset:29184
    v_mfma_f32_16x16x32_bf16 v[44:47], a[76:79], v[80:83], v[44:47]
    ds_read_b128 a[192:195], v162 offset:49152
    v_mfma_f32_16x16x32_bf16 v[16:19], v[120:123], v[84:87], v[16:19]
    ds_read_b128 a[208:211], v163 offset:49152
    v_mfma_f32_16x16x32_bf16 v[32:35], a[80:83], v[84:87], v[32:35]
    buffer_load_dwordx4 v155, s[28:31], s8 offen offset:1024 lds
    v_mfma_f32_16x16x32_bf16 v[36:39], a[84:87], v[84:87], v[36:39]
    ds_read_b128 a[196:199], v164 offset:49152
    ds_read_b128 a[212:215], v165 offset:49152
    v_mfma_f32_16x16x32_bf16 v[40:43], a[88:91], v[84:87], v[40:43]
    ds_read_b128 a[200:203], v166 offset:49152
    v_mfma_f32_16x16x32_bf16 v[44:47], a[92:95], v[84:87], v[44:47]
    s_nop 0
    ds_read_b128 a[216:219], v167 offset:49152
    s_waitcnt lgkmcnt(10)
    v_mfma_f32_16x16x32_bf16 v[28:31], a[160:163], a[160:163], v[28:31]
    s_add_u32 m0, s60, 139264
    s_add_u32 s8, s65, 2048
    buffer_load_dwordx4 v154, s[28:31], s8 offen offset:0 lds
    v_mfma_f32_16x16x32_bf16 v[112:115], v[120:123], a[160:163], v[112:115]
    ds_read_b128 a[204:207], v168 offset:49152
    v_mfma_f32_16x16x32_bf16 v[28:31], a[176:179], a[176:179], v[28:31]
    ds_read_b128 a[220:223], v169 offset:49152
    v_mfma_f32_16x16x32_bf16 v[112:115], v[120:123], a[176:179], v[112:115]
    buffer_load_dwordx4 v155, s[28:31], s8 offen offset:1024 lds
    s_waitcnt vmcnt(9)
    s_barrier
    s_waitcnt lgkmcnt(8)
    v_mfma_f32_16x16x32_bf16 v[16:19], v[120:123], v[88:91], v[16:19]
    s_nop 0
    ds_read_b64 v[240:241], v184 offset:0
    ds_read_b64 v[242:243], v184 offset:2048
    v_mfma_f32_16x16x32_bf16 v[32:35], a[96:99], v[88:91], v[32:35]
    ds_read_b64 v[244:245], v184 offset:4096
    v_mfma_f32_16x16x32_bf16 v[36:39], a[100:103], v[88:91], v[36:39]
    ds_read_b64 v[246:247], v184 offset:6144
    v_mfma_f32_16x16x32_bf16 v[40:43], a[104:107], v[88:91], v[40:43]
    ds_read_b64_tr_b16 v[64:65], v8 offset:32768
    ds_read_b64_tr_b16 v[66:67], v8 offset:33280
    v_mfma_f32_16x16x32_bf16 v[44:47], a[108:111], v[88:91], v[44:47]
    s_add_u32 m0, s60, 147456
    s_add_u32 s8, s66, 2048
    buffer_load_dwordx4 v154, s[28:31], s8 offen offset:0 lds
    v_mfma_f32_16x16x32_bf16 v[16:19], v[120:123], v[92:95], v[16:19]
    ds_read_b64_tr_b16 v[68:69], v8 offset:36864
    v_mfma_f32_16x16x32_bf16 v[32:35], a[112:115], v[92:95], v[32:35]
    ds_read_b64_tr_b16 v[70:71], v8 offset:37376
    v_mfma_f32_16x16x32_bf16 v[36:39], a[116:119], v[92:95], v[36:39]
    ds_read_b128 a[224:227], v162 offset:57344
    ds_read_b128 a[240:243], v163 offset:57344
    v_mfma_f32_16x16x32_bf16 v[40:43], a[120:123], v[92:95], v[40:43]
    ds_read_b128 a[228:231], v164 offset:57344
    v_mfma_f32_16x16x32_bf16 v[44:47], a[124:127], v[92:95], v[44:47]
    ds_read_b128 a[244:247], v165 offset:57344
    s_waitcnt lgkmcnt(12)
    v_mfma_f32_16x16x32_bf16 v[28:31], a[192:195], a[192:195], v[28:31]
    s_nop 0
    ds_read_b128 a[232:235], v166 offset:57344
    ds_read_b128 a[248:251], v167 offset:57344
    v_mfma_f32_16x16x32_bf16 v[112:115], v[120:123], a[192:195], v[112:115]
    ds_read_b128 a[236:239], v168 offset:57344
    v_mfma_f32_16x16x32_bf16 v[28:31], a[208:211], a[208:211], v[28:31]
    ds_read_b128 a[252:255], v169 offset:57344
    v_mfma_f32_16x16x32_bf16 v[112:115], v[120:123], a[208:211], v[112:115]
    buffer_load_dwordx4 v155, s[28:31], s8 offen offset:1024 lds
    s_waitcnt vmcnt(9)
    s_barrier
    s_waitcnt lgkmcnt(8)
    v_mfma_f32_16x16x32_bf16 v[16:19], v[120:123], v[64:67], v[16:19]
    s_nop 0
    ds_read_b64_tr_b16 v[72:73], v8 offset:40960
    v_mfma_f32_16x16x32_bf16 v[32:35], a[128:131], v[64:67], v[32:35]
    ds_read_b64_tr_b16 v[74:75], v8 offset:41472
    v_mfma_f32_16x16x32_bf16 v[36:39], a[132:135], v[64:67], v[36:39]
    v_mfma_f32_16x16x32_bf16 v[40:43], a[136:139], v[64:67], v[40:43]
    s_add_u32 m0, s60, 155648
    s_add_u32 s8, s67, 2048
    buffer_load_dwordx4 v154, s[28:31], s8 offen offset:0 lds
    v_mfma_f32_16x16x32_bf16 v[44:47], a[140:143], v[64:67], v[44:47]
    s_nop 0
    v_mfma_f32_16x16x32_bf16 v[16:19], v[120:123], v[68:71], v[16:19]
    s_nop 0
    ds_read_b64_tr_b16 v[76:77], v8 offset:45056
    v_mfma_f32_16x16x32_bf16 v[32:35], a[144:147], v[68:71], v[32:35]
    v_mfma_f32_16x16x32_bf16 v[36:39], a[148:151], v[68:71], v[36:39]
    ds_read_b64_tr_b16 v[78:79], v8 offset:45568
    v_mfma_f32_16x16x32_bf16 v[40:43], a[152:155], v[68:71], v[40:43]
    v_mfma_f32_16x16x32_bf16 v[44:47], a[156:159], v[68:71], v[44:47]
    s_nop 0
    buffer_load_dwordx4 v155, s[28:31], s8 offen offset:1024 lds
    s_waitcnt lgkmcnt(4)
    v_mfma_f32_16x16x32_bf16 v[28:31], a[224:227], a[224:227], v[28:31]
    v_mfma_f32_16x16x32_bf16 v[112:115], v[120:123], a[224:227], v[112:115]
    v_mfma_f32_16x16x32_bf16 v[28:31], a[240:243], a[240:243], v[28:31]
    v_mfma_f32_16x16x32_bf16 v[112:115], v[120:123], a[240:243], v[112:115]
    s_waitcnt vmcnt(6)
    s_barrier
    s_cmp_eq_u32 s19, 0
    s_cbranch_scc1 L_nc_3
    s_xor_b32 s56, s19, 0x2000
    buffer_store_dwordx4 v[96:99], v1, s[48:51], s19 offen sc1
    buffer_store_dwordx4 v[96:99], v12, s[48:51], s19 offen sc1
    buffer_store_dwordx4 v[96:99], v1, s[48:51], s56 offen sc1
    buffer_store_dwordx4 v[96:99], v12, s[48:51], s56 offen sc1
L_nc_3:
    s_cmp_eq_u32 s52, 0
    s_cbranch_scc0 L_ns_4
    s_lshl3_add_u32 s56, s53, s54
    s_lshl_b32 s56, s56, 9
    s_add_u32 s56, s56, 131072
    v_lshlrev_b32_e64 v189, 3, v10
    buffer_store_dwordx2 v[96:97], v189, s[48:51], s56 offen sc1
L_ns_4:
    s_waitcnt lgkmcnt(0)
    v_mfma_f32_16x16x32_bf16 v[16:19], v[120:123], v[72:75], v[16:19]
    s_nop 0
    ds_read_b64_tr_b16 v[80:81], v8 offset:49152
    ds_read_b64_tr_b16 v[82:83], v8 offset:49664
    s_mov_b32 vcc_lo, 0xcccccccc
    v_mfma_f32_16x16x32_bf16 v[32:35], a[160:163], v[72:75], v[32:35]
    s_add_u32 m0, s60, 0
    s_add_u32 s8, s68, 2048
    s_nop 0
    buffer_load_dwordx4 v154, s[28:31], s8 offen offset:0 lds
    s_mov_b32 vcc_hi, 0xcccccccc
    v_cndmask_b32 v28, v28, v29, s[12:13]
    v_mfma_f32_16x16x32_bf16 v[36:39], a[164:167], v[72:75], v[36:39]
    ds_read_b64_tr_b16 v[84:85], v8 offset:53248
    v_cndmask_b32 v30, v30, v31, s[12:13]
    v_mfma_f32_16x16x32_bf16 v[40:43], a[168:171], v[72:75], v[40:43]
    ds_read_b64_tr_b16 v[86:87], v8 offset:53760
    v_mul_f32 v112, 0xbb000000, v112
    v_cndmask_b32_e64 v28, v28, v30, vcc
    v_mfma_f32_16x16x32_bf16 v[44:47], a[172:175], v[72:75], v[44:47]
    buffer_load_dwordx4 v155, s[28:31], s8 offen offset:1024 lds
    v_mul_f32 v28, 0x3b000000, v28
    v_fma_f32 v28, -v112, v112, v28
    v_mfma_f32_16x16x32_bf16 v[16:19], v[120:123], v[76:79], v[16:19]
    ds_read_b64_tr_b16 v[88:89], v8 offset:57344
    ds_read_b64_tr_b16 v[90:91], v8 offset:57856
    v_max_f32_e64 v28, 0, v28
    v_mfma_f32_16x16x32_bf16 v[32:35], a[176:179], v[76:79], v[32:35]
    ds_read_b64_tr_b16 v[92:93], v8 offset:61440
    v_add_f32 v28, 0x3727c5ac, v28
    v_mfma_f32_16x16x32_bf16 v[36:39], a[180:183], v[76:79], v[36:39]
    s_add_u32 m0, s60, 8192
    s_add_u32 s8, s69, 2048
    buffer_load_dwordx4 v154, s[28:31], s8 offen offset:0 lds
    v_rsq_f32_e64 v28, v28
    v_mfma_f32_16x16x32_bf16 v[40:43], a[184:187], v[76:79], v[40:43]
    s_mov_b32 exec_lo, 0x00f0000f
    s_mov_b32 exec_hi, 0xf0000f00
    ds_write2_b32 v175, v112, v28 offset1:64
    s_mov_b64 exec, -1
    ds_read_b64_tr_b16 v[94:95], v8 offset:61952
    v_mfma_f32_16x16x32_bf16 v[44:47], a[188:191], v[76:79], v[44:47]
    buffer_load_dwordx4 v155, s[28:31], s8 offen offset:1024 lds
    s_waitcnt vmcnt(8) lgkmcnt(1)
    s_barrier
    v_readfirstlane_b32 s56, v186
    s_nop 0
    s_and_b32 s57, s56, 0xf0
    s_cbranch_scc0 L_again_2
L_ok_1:
    s_lshr_b32 s56, s56, 7
    s_cmp_gt_u32 s56, s57
    s_cselect_b32 s12, 0x2000, 0
    s_xor_b32 s9, s9, s12
    s_xor_b32 s16, s16, s12
    v_mfma_f32_16x16x32_bf16 v[16:19], v[120:123], v[80:83], v[16:19]
    buffer_store_dwordx4 v[96:99], v1, s[48:51], s16 offen sc1
    ds_read_b128 v[192:195], v171
    v_mfma_f32_16x16x32_bf16 v[32:35], a[192:195], v[80:83], v[32:35]
    ds_read_b128 v[208:211], v171 offset:256
    v_mfma_f32_16x16x32_bf16 v[36:39], a[196:199], v[80:83], v[36:39]
    s_add_u32 m0, s60, 16384
    s_add_u32 s8, s70, 2048
    buffer_load_dwordx4 v154, s[28:31], s8 offen offset:0 lds
    v_mfma_f32_16x16x32_bf16 v[40:43], a[200:203], v[80:83], v[40:43]
    ds_read_b128 v[196:199], v172
    v_mfma_f32_16x16x32_bf16 v[44:47], a[204:207], v[80:83], v[44:47]
    ds_read_b128 v[212:215], v172 offset:256
    v_mfma_f32_16x16x32_bf16 v[16:19], v[120:123], v[84:87], v[16:19]
    buffer_store_dwordx4 v[96:99], v12, s[48:51], s16 offen sc1
    v_mfma_f32_16x16x32_bf16 v[32:35], a[208:211], v[84:87], v[32:35]
    ds_read_b128 v[200:203], v173
    v_mfma_f32_16x16x32_bf16 v[36:39], a[212:215], v[84:87], v[36:39]
    ds_read_b128 v[216:219], v173 offset:256
    v_mfma_f32_16x16x32_bf16 v[40:43], a[216:219], v[84:87], v[40:43]
    ds_read_b128 v[204:207], v174
    v_mfma_f32_16x16x32_bf16 v[44:47], a[220:223], v[84:87], v[44:47]
    s_nop 0
    buffer_load_dwordx4 v155, s[28:31], s8 offen offset:1024 lds
    s_waitcnt lgkmcnt(7)
    v_mfma_f32_16x16x32_bf16 v[16:19], v[120:123], v[88:91], v[16:19]
    ds_read_b128 v[220:223], v174 offset:256
    ds_read_b64_tr_b16 v[64:65], v9 offset:0
    v_mfma_f32_16x16x32_bf16 v[32:35], a[224:227], v[88:91], v[32:35]
    ds_read_b64_tr_b16 v[66:67], v9 offset:512
    v_mfma_f32_16x16x32_bf16 v[36:39], a[228:231], v[88:91], v[36:39]
    ds_read_b64_tr_b16 v[68:69], v9 offset:4096
    v_mfma_f32_16x16x32_bf16 v[40:43], a[232:235], v[88:91], v[40:43]
    ds_read_b64_tr_b16 v[70:71], v9 offset:4608
    v_mfma_f32_16x16x32_bf16 v[44:47], a[236:239], v[88:91], v[44:47]
    ds_read_b64_tr_b16 v[72:73], v9 offset:8192
    v_mfma_f32_16x16x32_bf16 v[16:19], v[120:123], v[92:95], v[16:19]
    s_add_u32 m0, s60, 24576
    s_add_u32 s8, s71, 2048
    buffer_load_dwordx4 v154, s[28:31], s8 offen offset:0 lds
    v_mfma_f32_16x16x32_bf16 v[32:35], a[240:243], v[92:95], v[32:35]
    ds_read_b64_tr_b16 v[74:75], v9 offset:8704
    v_mfma_f32_16x16x32_bf16 v[36:39], a[244:247], v[92:95], v[36:39]
    ds_read_b64_tr_b16 v[76:77], v9 offset:12288
    v_mfma_f32_16x16x32_bf16 v[40:43], a[248:251], v[92:95], v[40:43]
    ds_read_b64_tr_b16 v[78:79], v9 offset:12800
    v_mfma_f32_16x16x32_bf16 v[44:47], a[252:255], v[92:95], v[44:47]
    s_nop 0
    buffer_load_dwordx4 v155, s[28:31], s8 offen offset:1024 lds
    s_waitcnt vmcnt(10)
    s_barrier
    s_waitcnt lgkmcnt(4)
    v_mfma_f32_16x16x32_bf16 v[20:23], v[120:123], v[64:67], 0
    ds_read2_b32 v[248:249], v175 offset1:64
    v_fma_f32 v32, v192, v16, v32
    v_mfma_f32_16x16x32_bf16 v[48:51], a[0:3], v[64:67], 0
    ds_read2_b32 v[250:251], v176 offset1:64
    v_fma_f32 v32, v32, v208, v124
    v_fmamk_f32 v136, v32, 0x3fb8aa3b, v15
    v_mfma_f32_16x16x32_bf16 v[52:55], a[4:7], v[64:67], 0
    s_add_u32 m0, s60, 32768
    s_add_u32 s8, s64, 0
    buffer_load_dwordx4 v154, s[28:31], s8 offen offset:0 lds
    v_exp_f32_e64 v136, v136 clamp
    v_mfma_f32_16x16x32_bf16 v[56:59], a[8:11], v[64:67], 0
    ds_read2_b32 v[252:253], v177 offset1:64
    v_max_f32 v32, v32, v124
    v_mfma_f32_16x16x32_bf16 v[60:63], a[12:15], v[64:67], 0
    ds_read2_b32 v[254:255], v178 offset1:64
    v_add_f32_e64 v32, v32, v136
    v_mfma_f32_16x16x32_bf16 v[20:23], v[120:123], v[68:71], v[20:23]
    ds_read_b64_tr_b16 v[80:81], v9 offset:16384
    v_mul_f32_e64 v136, v32, v208
    v_mfma_f32_16x16x32_bf16 v[48:51], a[16:19], v[68:71], v[48:51]
    buffer_load_dwordx4 v155, s[28:31], s8 offen offset:1024 lds
    v_fma_f32 v33, v193, v16, v33
    v_fma_f32 v33, v33, v209, v124
    v_mfma_f32_16x16x32_bf16 v[52:55], a[20:23], v[68:71], v[52:55]
    ds_read_b64_tr_b16 v[82:83], v9 offset:16896
    v_fmamk_f32 v137, v33, 0x3fb8aa3b, v15
    v_mfma_f32_16x16x32_bf16 v[56:59], a[24:27], v[68:71], v[56:59]
    ds_read_b64_tr_b16 v[84:85], v9 offset:20480
    v_exp_f32_e64 v137, v137 clamp
    v_mfma_f32_16x16x32_bf16 v[60:63], a[28:31], v[68:71], v[60:63]
    ds_read_b64_tr_b16 v[86:87], v9 offset:20992
    v_max_f32 v33, v33, v124
    s_waitcnt lgkmcnt(8)
    v_mfma_f32_16x16x32_bf16 v[20:23], v[120:123], v[72:75], v[20:23]
    s_add_u32 m0, s60, 98304
    s_xor_b32 s8, s72, 0
    buffer_load_dwordx4 v156, s[32:35], s8 offen offset:0 lds
    v_add_f32 v33, v33, v137
    v_mfma_f32_16x16x32_bf16 v[48:51], a[32:35], v[72:75], v[48:51]
    ds_read_b64_tr_b16 v[88:89], v9 offset:24576
    v_mul_f32_e64 v137, v33, v209
    v_cvt_pk_bf16_f32 v96, v32, v33
    v_mfma_f32_16x16x32_bf16 v[52:55], a[36:39], v[72:75], v[52:55]
    ds_read_b64_tr_b16 v[90:91], v9 offset:25088
    v_cvt_pk_bf16_f32 v104, v136, v137
    v_mfma_f32_16x16x32_bf16 v[56:59], a[40:43], v[72:75], v[56:59]
    ds_read_b64_tr_b16 v[92:93], v9 offset:28672
    v_fma_f32 v34, v194, v16, v34
    v_fma_f32 v34, v34, v210, v124
    v_mfma_f32_16x16x32_bf16 v[60:63], a[44:47], v[72:75], v[60:63]
    ds_read_b64_tr_b16 v[94:95], v9 offset:29184
    v_fmamk_f32 v138, v34, 0x3fb8aa3b, v15
    v_mfma_f32_16x16x32_bf16 v[20:23], v[120:123], v[76:79], v[20:23]
    buffer_load_dwordx4 v157, s[32:35], s8 offen offset:1024 lds
    v_exp_f32_e64 v138, v138 clamp
    v_mfma_f32_16x16x32_bf16 v[48:51], a[48:51], v[76:79], v[48:51]
    buffer_load_dword v191, v191, s[36:39], 0 offen
    v_max_f32_e64 v34, v34, v124
    v_mfma_f32_16x16x32_bf16 v[52:55], a[52:55], v[76:79], v[52:55]
    v_add_f32_e64 v34, v34, v138
    v_mul_f32_e64 v138, v34, v210
    v_mfma_f32_16x16x32_bf16 v[56:59], a[56:59], v[76:79], v[56:59]
    v_fma_f32 v35, v195, v16, v35
    v_fma_f32 v35, v35, v211, v124
    v_fmamk_f32 v139, v35, 0x3fb8aa3b, v15
    v_mfma_f32_16x16x32_bf16 v[60:63], a[60:63], v[76:79], v[60:63]
    s_nop 0
    v_exp_f32_e64 v139, v139 clamp
    s_waitcnt vmcnt(11)
    s_barrier
    s_waitcnt lgkmcnt(4)
    v_mfma_f32_16x16x32_bf16 v[20:23], v[120:123], v[80:83], v[20:23]
    ds_read_b64_tr_b16 v[64:65], v7 offset:0
    v_max_f32_e64 v35, v35, v124
    v_mfma_f32_16x16x32_bf16 v[48:51], a[64:67], v[80:83], v[48:51]
    v_add_f32 v35, v35, v139
    v_mul_f32 v139, v35, v211
    v_mfma_f32_16x16x32_bf16 v[52:55], a[68:71], v[80:83], v[52:55]
    ds_read_b64_tr_b16 v[66:67], v7 offset:512
    v_cvt_pk_bf16_f32 v97, v34, v35
    v_mfma_f32_16x16x32_bf16 v[56:59], a[72:75], v[80:83], v[56:59]
    v_cvt_pk_bf16_f32 v105, v138, v139
    v_fma_f32 v36, v196, v16, v36
    v_mfma_f32_16x16x32_bf16 v[60:63], a[76:79], v[80:83], v[60:63]
    ds_read_b64_tr_b16 v[68:69], v7 offset:4096
    v_fma_f32 v36, v36, v212, v124
    v_fmamk_f32 v140, v36, 0x3fb8aa3b, v15
    v_mfma_f32_16x16x32_bf16 v[20:23], v[120:123], v[84:87], v[20:23]
    v_exp_f32_e64 v140, v140 clamp
    v_mfma_f32_16x16x32_bf16 v[48:51], a[80:83], v[84:87], v[48:51]
    ds_read_b64_tr_b16 v[70:71], v7 offset:4608
    v_max_f32_e64 v36, v36, v124
    v_mfma_f32_16x16x32_bf16 v[52:55], a[84:87], v[84:87], v[52:55]
    v_add_f32_e64 v36, v36, v140
    v_mul_f32_e64 v140, v36, v212
    v_mfma_f32_16x16x32_bf16 v[56:59], a[88:91], v[84:87], v[56:59]
    ds_read_b64_tr_b16 v[72:73], v7 offset:8192
    v_fma_f32 v37, v197, v16, v37
    v_mfma_f32_16x16x32_bf16 v[60:63], a[92:95], v[84:87], v[60:63]
    v_fma_f32 v37, v37, v213, v124
    v_fmamk_f32 v141, v37, 0x3fb8aa3b, v15
    s_waitcnt lgkmcnt(5)
    v_mfma_f32_16x16x32_bf16 v[20:23], v[120:123], v[88:91], v[20:23]
    s_nop 0
    ds_read_b64_tr_b16 v[74:75], v7 offset:8704
    v_exp_f32_e64 v141, v141 clamp
    v_mfma_f32_16x16x32_bf16 v[48:51], a[96:99], v[88:91], v[48:51]
    v_max_f32_e64 v37, v37, v124
    v_mfma_f32_16x16x32_bf16 v[52:55], a[100:103], v[88:91], v[52:55]
    ds_read_b64_tr_b16 v[76:77], v7 offset:12288
    v_add_f32 v37, v37, v141
    v_mfma_f32_16x16x32_bf16 v[56:59], a[104:107], v[88:91], v[56:59]
    v_mul_f32 v141, v37, v213
    v_cvt_pk_bf16_f32 v98, v36, v37
    v_mfma_f32_16x16x32_bf16 v[60:63], a[108:111], v[88:91], v[60:63]
    ds_read_b64_tr_b16 v[78:79], v7 offset:12800
    v_cvt_pk_bf16_f32 v106, v140, v141
    v_fma_f32 v38, v198, v16, v38
    v_mfma_f32_16x16x32_bf16 v[20:23], v[120:123], v[92:95], v[20:23]
    v_fma_f32 v38, v38, v214, v124
    v_fmamk_f32 v142, v38, 0x3fb8aa3b, v15
    v_mfma_f32_16x16x32_bf16 v[48:51], a[112:115], v[92:95], v[48:51]
    v_exp_f32_e64 v142, v142 clamp
    v_mfma_f32_16x16x32_bf16 v[52:55], a[116:119], v[92:95], v[52:55]
    v_max_f32_e64 v38, v38, v124
    v_add_f32_e64 v38, v38, v142
    v_mfma_f32_16x16x32_bf16 v[56:59], a[120:123], v[92:95], v[56:59]
    v_mul_f32_e64 v142, v38, v214
    v_fma_f32 v39, v199, v16, v39
    v_mfma_f32_16x16x32_bf16 v[60:63], a[124:127], v[92:95], v[60:63]
    v_fma_f32 v39, v39, v215, v124
    v_fmamk_f32 v143, v39, 0x3fb8aa3b, v15
    s_waitcnt vmcnt(5)
    s_barrier
    s_waitcnt lgkmcnt(4)
    v_mfma_f32_16x16x32_bf16 v[20:23], v[120:123], v[64:67], v[20:23]
    s_nop 0
    ds_read_b64_tr_b16 v[80:81], v7 offset:16384
    v_exp_f32_e64 v143, v143 clamp
    v_mfma_f32_16x16x32_bf16 v[48:51], a[128:131], v[64:67], v[48:51]
    v_max_f32_e64 v39, v39, v124
    v_mfma_f32_16x16x32_bf16 v[52:55], a[132:135], v[64:67], v[52:55]
    ds_read_b64_tr_b16 v[82:83], v7 offset:16896
    v_add_f32 v39, v39, v143
    v_mul_f32 v143, v39, v215
    v_mfma_f32_16x16x32_bf16 v[56:59], a[136:139], v[64:67], v[56:59]
    v_cvt_pk_bf16_f32 v99, v38, v39
    v_cvt_pk_bf16_f32 v107, v142, v143
    v_mfma_f32_16x16x32_bf16 v[60:63], a[140:143], v[64:67], v[60:63]
    ds_read_b64_tr_b16 v[84:85], v7 offset:20480
    v_fma_f32 v40, v200, v16, v40
    v_mfma_f32_16x16x32_bf16 v[20:23], v[120:123], v[68:71], v[20:23]
    v_fma_f32 v40, v40, v216, v124
    v_fmamk_f32 v144, v40, 0x3fb8aa3b, v15
    v_mfma_f32_16x16x32_bf16 v[48:51], a[144:147], v[68:71], v[48:51]
    ds_read_b64_tr_b16 v[86:87], v7 offset:20992
    v_exp_f32_e64 v144, v144 clamp
    v_mfma_f32_16x16x32_bf16 v[52:55], a[148:151], v[68:71], v[52:55]
    v_max_f32_e64 v40, v40, v124
    v_add_f32_e64 v40, v40, v144
    v_mfma_f32_16x16x32_bf16 v[56:59], a[152:155], v[68:71], v[56:59]
    ds_read_b64_tr_b16 v[88:89], v7 offset:24576
    v_mul_f32_e64 v144, v40, v216
    v_mfma_f32_16x16x32_bf16 v[60:63], a[156:159], v[68:71], v[60:63]
    v_fma_f32 v41, v201, v16, v41
    v_fma_f32 v41, v41, v217, v124
    s_waitcnt lgkmcnt(5)
    v_mfma_f32_16x16x32_bf16 v[20:23], v[120:123], v[72:75], v[20:23]
    s_nop 0
    ds_read_b64_tr_b16 v[90:91], v7 offset:25088
    v_fmamk_f32 v145, v41, 0x3fb8aa3b, v15
    v_mfma_f32_16x16x32_bf16 v[48:51], a[160:163], v[72:75], v[48:51]
    v_exp_f32_e64 v145, v145 clamp
    v_mfma_f32_16x16x32_bf16 v[52:55], a[164:167], v[72:75], v[52:55]
    ds_read_b64_tr_b16 v[92:93], v7 offset:28672
    v_max_f32 v41, v41, v124
    v_add_f32 v41, v41, v145
    v_mfma_f32_16x16x32_bf16 v[56:59], a[168:171], v[72:75], v[56:59]
    v_mul_f32_e64 v145, v41, v217
    v_cvt_pk_bf16_f32 v100, v40, v41
    v_mfma_f32_16x16x32_bf16 v[60:63], a[172:175], v[72:75], v[60:63]
    ds_read_b64_tr_b16 v[94:95], v7 offset:29184
    v_cvt_pk_bf16_f32 v108, v144, v145
    v_mfma_f32_16x16x32_bf16 v[20:23], v[120:123], v[76:79], v[20:23]
    v_fma_f32 v42, v202, v16, v42
    v_fma_f32 v42, v42, v218, v124
    v_mfma_f32_16x16x32_bf16 v[48:51], a[176:179], v[76:79], v[48:51]
    v_fmamk_f32 v146, v42, 0x3fb8aa3b, v15
    v_exp_f32_e64 v146, v146 clamp
    v_mfma_f32_16x16x32_bf16 v[52:55], a[180:183], v[76:79], v[52:55]
    v_max_f32 v42, v42, v124
    v_add_f32 v42, v42, v146
    v_mfma_f32_16x16x32_bf16 v[56:59], a[184:187], v[76:79], v[56:59]
    v_mul_f32_e64 v146, v42, v218
    v_fma_f32 v43, v203, v16, v43
    v_mfma_f32_16x16x32_bf16 v[60:63], a[188:191], v[76:79], v[60:63]
    v_fma_f32 v43, v43, v219, v124
    v_fmamk_f32 v147, v43, 0x3fb8aa3b, v15
    s_add_u32 s56, s9, 114688
    s_mov_b64 exec, 1
    buffer_atomic_add v188, v13, s[48:51], s56 offen
    s_mov_b64 exec, -1
    s_waitcnt lgkmcnt(4)
    v_mfma_f32_16x16x32_bf16 v[20:23], v[120:123], v[80:83], v[20:23]
    s_nop 0
    v_exp_f32_e64 v147, v147 clamp
    v_mfma_f32_16x16x32_bf16 v[48:51], a[192:195], v[80:83], v[48:51]
    v_max_f32 v43, v43, v124
    v_add_f32 v43, v43, v147
    v_mul_f32_e64 v147, v43, v219
    v_mfma_f32_16x16x32_bf16 v[52:55], a[196:199], v[80:83], v[52:55]
    v_cvt_pk_bf16_f32 v101, v42, v43
    v_cvt_pk_bf16_f32 v109, v146, v147
    v_mfma_f32_16x16x32_bf16 v[56:59], a[200:203], v[80:83], v[56:59]
    v_fma_f32 v44, v204, v16, v44
    v_fma_f32 v44, v44, v220, v124
    v_mfma_f32_16x16x32_bf16 v[60:63], a[204:207], v[80:83], v[60:63]
    v_fmamk_f32 v148, v44, 0x3fb8aa3b, v15
    v_exp_f32_e64 v148, v148 clamp
    v_mfma_f32_16x16x32_bf16 v[20:23], v[120:123], v[84:87], v[20:23]
    v_max_f32 v44, v44, v124
    v_add_f32 v44, v44, v148
    v_mfma_f32_16x16x32_bf16 v[48:51], a[208:211], v[84:87], v[48:51]
    v_mul_f32_e64 v148, v44, v220
    v_fma_f32 v45, v205, v16, v45
    v_mfma_f32_16x16x32_bf16 v[52:55], a[212:215], v[84:87], v[52:55]
    v_fma_f32 v45, v45, v221, v124
    v_fmamk_f32 v149, v45, 0x3fb8aa3b, v15
    v_mfma_f32_16x16x32_bf16 v[56:59], a[216:219], v[84:87], v[56:59]
    v_exp_f32_e64 v149, v149 clamp
    v_max_f32_e64 v45, v45, v124
    v_mfma_f32_16x16x32_bf16 v[60:63], a[220:223], v[84:87], v[60:63]
    v_add_f32_e64 v45, v45, v149
    v_mul_f32 v149, v45, v221
    v_cvt_pk_bf16_f32 v102, v44, v45
    s_waitcnt lgkmcnt(0)
    v_mfma_f32_16x16x32_bf16 v[20:23], v[120:123], v[88:91], v[20:23]
    v_cvt_pk_bf16_f32 v110, v148, v149
    v_fma_f32 v46, v206, v16, v46
    v_mfma_f32_16x16x32_bf16 v[48:51], a[224:227], v[88:91], v[48:51]
    v_fma_f32 v46, v46, v222, v124
    v_fmamk_f32 v150, v46, 0x3fb8aa3b, v15
    v_mfma_f32_16x16x32_bf16 v[52:55], a[228:231], v[88:91], v[52:55]
    v_exp_f32_e64 v150, v150 clamp
    v_max_f32 v46, v46, v124
    v_mfma_f32_16x16x32_bf16 v[56:59], a[232:235], v[88:91], v[56:59]
    v_add_f32 v46, v46, v150
    v_mul_f32_e64 v150, v46, v222
    v_mfma_f32_16x16x32_bf16 v[60:63], a[236:239], v[88:91], v[60:63]
    v_fma_f32 v47, v207, v16, v47
    v_fma_f32 v47, v47, v223, v124
    v_mfma_f32_16x16x32_bf16 v[20:23], v[120:123], v[92:95], v[20:23]
    v_fmamk_f32 v151, v47, 0x3fb8aa3b, v15
    v_exp_f32_e64 v151, v151 clamp
    v_mfma_f32_16x16x32_bf16 v[48:51], a[240:243], v[92:95], v[48:51]
    v_max_f32 v47, v47, v124
    v_add_f32 v47, v47, v151
    v_mfma_f32_16x16x32_bf16 v[52:55], a[244:247], v[92:95], v[52:55]
    v_mul_f32_e64 v151, v47, v223
    v_cvt_pk_bf16_f32 v103, v46, v47
    v_mfma_f32_16x16x32_bf16 v[56:59], a[248:251], v[92:95], v[56:59]
    v_cvt_pk_bf16_f32 v111, v150, v151
    v_mfma_f32_16x16x32_bf16 v[116:119], v[96:99], v[120:123], 0
    v_mfma_f32_16x16x32_bf16 v[60:63], a[252:255], v[92:95], v[60:63]
    v_mfma_f32_16x16x32_bf16 v[116:119], v[100:103], v[120:123], v[116:119]
    v_pk_fma_f32 v[48:49], v[192:193], v[20:21], v[48:49]
    v_cvt_pk_bf16_f32 v128, v48, v49
    v_pk_fma_f32 v[50:51], v[194:195], v[20:21], v[50:51]
    v_cvt_pk_bf16_f32 v129, v50, v51
    v_pk_fma_f32 v[52:53], v[196:197], v[20:21], v[52:53]
    v_cvt_pk_bf16_f32 v130, v52, v53
    v_pk_fma_f32 v[54:55], v[198:199], v[20:21], v[54:55]
    v_cvt_pk_bf16_f32 v131, v54, v55
    v_pk_fma_f32 v[56:57], v[200:201], v[20:21], v[56:57]
    v_cvt_pk_bf16_f32 v132, v56, v57
    v_pk_fma_f32 v[58:59], v[202:203], v[20:21], v[58:59]
    v_cvt_pk_bf16_f32 v133, v58, v59
    v_pk_fma_f32 v[60:61], v[204:205], v[20:21], v[60:61]
    v_cvt_pk_bf16_f32 v134, v60, v61
    v_pk_fma_f32 v[62:63], v[206:207], v[20:21], v[62:63]
    v_cvt_pk_bf16_f32 v135, v62, v63
    v_mfma_f32_16x16x32_bf16 v[112:115], v[104:107], v[128:131], 0
    v_min_u32 v116, -2, v116
    v_mfma_f32_16x16x32_bf16 v[112:115], v[108:111], v[132:135], v[112:115]
    v_min_u32 v117, -2, v117
    v_min_u32 v118, -2, v118
    v_min_u32 v119, -2, v119
    buffer_store_dwordx4 v[116:119], v12, s[48:51], s16 offen sc1
    s_nop 3
    v_min_u32 v112, -2, v112
    v_min_u32 v113, -2, v113
    v_min_u32 v114, -2, v114
    v_min_u32 v115, -2, v115
    buffer_store_dwordx4 v[112:115], v1, s[48:51], s16 offen sc1
    s_cmp_lg_u32 s19, 0
    s_cbranch_scc1 L_red_5
    s_lshr_b32 s24, s72, 2
    s_xor_b32 s18, s18, s12
    v_mov_b32 v187, 0
    s_xor_b32 s61, s61, s12
    s_and_b32 s13, s61, 0x2000
    s_and_b32 s57, s54, 1
    s_lshl2_add_u32 s25, s53, s57
    s_lshl_b32 s25, s25, 7
    s_xor_b32 s25, s25, s12
    s_lshr_b32 s58, s52, 1
    s_bfe_u32 s56, s11, 0x10002
    s_lshl1_add_u32 s21, s10, s56
    s_xor_b32 s14, s21, s58
    s_xor_b32 s14, s14, 1
    s_and_b32 s57, s52, 1
    s_lshl2_add_u32 s26, s14, s57
    s_and_b32 s56, s11, 3
    s_lshl2_add_u32 s27, s21, s56
    s_lshl_b32 s26, s26, 7
    s_lshl_b32 s27, s27, 7
    s_xor_b32 s26, s26, s12
    s_xor_b32 s27, s27, s12
    s_lshl_b32 s20, s58, 15
    s_lshl_b32 s56, s57, 12
    s_add_u32 s20, s20, s56
    s_lshl_b32 s57, s57, 8
    s_lshl_b32 s58, s58, 10
    s_or_b32 s57, s57, s58
    v_xor_b32 v13, s57, v1
    v_xor_b32 v14, 1024, v13
    v_lshlrev_b32_e64 v16, 16, v240
    v_and_b32 v17, 0xffff0000, v240
L_pad1:
    s_cbranch_execz L_back
    v_lshlrev_b32 v18, 16, v241
    v_and_b32 v19, 0xffff0000, v241
    v_lshlrev_b32_e64 v20, 16, v242
    v_and_b32 v21, 0xffff0000, v242
    v_lshlrev_b32_e64 v22, 16, v243
    v_and_b32 v23, 0xffff0000, v243
    v_lshlrev_b32_e64 v24, 16, v244
    v_and_b32 v25, 0xffff0000, v244
    v_lshlrev_b32_e64 v26, 16, v245
    v_and_b32 v27, 0xffff0000, v245
    v_lshlrev_b32_e64 v28, 16, v246
    v_and_b32 v29, 0xffff0000, v246
    v_lshlrev_b32_e64 v30, 16, v247
    v_and_b32 v31, 0xffff0000, v247
    v_and_b32 v116, 15, v10
    v_cmp_eq_u32 vcc, 0, v116
    s_nop 1
    v_cndmask_b32 v116, 0, v120, vcc
    v_mov_b32 v117, v116
    v_mov_b32 v118, v116
    v_mov_b32_e64 v119, v116
    s_and_b32 s56, s53, 15
    s_lshl_b32 s56, s56, 17
    s_add_u32 s56, s56, s60
    s_xor_b32 s57, s13, 2105344
    s_add_u32 s16, s56, s57
    s_lshl_b32 s57, s54, 14
    s_add_u32 s59, s16, s57
    v_mov_b32 v128, 0x3fb8aa3b
    v_mov_b32 v129, v15
    s_add_u32 m0, s60, 40960
    s_add_u32 s8, s65, 0
    buffer_load_dwordx4 v154, s[28:31], s8 offen offset:0 lds
    buffer_load_dwordx4 v155, s[28:31], s8 offen offset:1024 lds
    s_add_u32 m0, s60, 49152
    s_add_u32 s8, s66, 0
    buffer_load_dwordx4 v154, s[28:31], s8 offen offset:0 lds
    buffer_load_dwordx4 v155, s[28:31], s8 offen offset:1024 lds
    s_add_u32 m0, s60, 57344
    s_add_u32 s8, s67, 0
    buffer_load_dwordx4 v154, s[28:31], s8 offen offset:0 lds
    buffer_load_dwordx4 v155, s[28:31], s8 offen offset:1024 lds
    s_add_u32 m0, s60, 65536
    s_add_u32 s8, s68, 0
    buffer_load_dwordx4 v154, s[28:31], s8 offen offset:0 lds
    buffer_load_dwordx4 v155, s[28:31], s8 offen offset:1024 lds
    s_add_u32 m0, s60, 73728
    s_add_u32 s8, s69, 0
    buffer_load_dwordx4 v154, s[28:31], s8 offen offset:0 lds
    buffer_load_dwordx4 v155, s[28:31], s8 offen offset:1024 lds
    s_waitcnt vmcnt(8)
    s_barrier
    ds_read_b64_tr_b16 v[64:65], v7 offset:32768
    ds_read_b64_tr_b16 v[66:67], v7 offset:33280
    ds_read_b64_tr_b16 v[68:69], v7 offset:36864
    s_add_u32 m0, s60, 81920
    s_nop 0
    s_add_u32 s8, s70, 0
    buffer_load_dwordx4 v154, s[28:31], s8 offen offset:0 lds
    ds_read_b64_tr_b16 v[70:71], v7 offset:37376
    ds_read_b64_tr_b16 v[72:73], v7 offset:40960
    ds_read_b64_tr_b16 v[74:75], v7 offset:41472
    ds_read_b64_tr_b16 v[76:77], v7 offset:45056
    ds_read_b64_tr_b16 v[78:79], v7 offset:45568
    buffer_load_dwordx4 v155, s[28:31], s8 offen offset:1024 lds
    s_waitcnt vmcnt(6)
    s_barrier
    s_waitcnt lgkmcnt(4)
    v_mfma_f32_16x16x32_bf16 v[104:107], v[64:67], v[120:123], 0
    s_nop 0
    ds_read_b64_tr_b16 v[80:81], v7 offset:49152
    v_mfma_f32_16x16x32_bf16 v[32:35], v[64:67], a[0:3], 0
    ds_read_b64_tr_b16 v[82:83], v7 offset:49664
    v_mfma_f32_16x16x32_bf16 v[36:39], v[64:67], a[4:7], 0
    s_add_u32 m0, s60, 90112
    s_add_u32 s8, s71, 0
    buffer_load_dwordx4 v154, s[28:31], s8 offen offset:0 lds
    v_mfma_f32_16x16x32_bf16 v[40:43], v[64:67], a[8:11], 0
    s_nop 0
    v_mfma_f32_16x16x32_bf16 v[44:47], v[64:67], a[12:15], 0
    ds_read_b64_tr_b16 v[84:85], v7 offset:53248
    v_mfma_f32_16x16x32_bf16 v[104:107], v[68:71], v[120:123], v[104:107]
    ds_read_b64_tr_b16 v[86:87], v7 offset:53760
    v_mfma_f32_16x16x32_bf16 v[32:35], v[68:71], a[16:19], v[32:35]
    buffer_load_dwordx4 v155, s[28:31], s8 offen offset:1024 lds
    v_mfma_f32_16x16x32_bf16 v[36:39], v[68:71], a[20:23], v[36:39]
    v_mfma_f32_16x16x32_bf16 v[40:43], v[68:71], a[24:27], v[40:43]
    ds_read_b64_tr_b16 v[88:89], v7 offset:57344
    v_mfma_f32_16x16x32_bf16 v[44:47], v[68:71], a[28:31], v[44:47]
    s_nop 0
    ds_read_b64_tr_b16 v[90:91], v7 offset:57856
    s_waitcnt lgkmcnt(6)
    v_mfma_f32_16x16x32_bf16 v[104:107], v[72:75], v[120:123], v[104:107]
    ds_read_b64_tr_b16 v[92:93], v7 offset:61440
    v_mfma_f32_16x16x32_bf16 v[32:35], v[72:75], a[32:35], v[32:35]
    v_mfma_f32_16x16x32_bf16 v[36:39], v[72:75], a[36:39], v[36:39]
    s_add_u32 m0, s60, 106496
    s_xor_b32 s8, s72, 65536
    buffer_load_dwordx4 v156, s[32:35], s8 offen offset:0 lds
    v_mfma_f32_16x16x32_bf16 v[40:43], v[72:75], a[40:43], v[40:43]
    ds_read_b64_tr_b16 v[94:95], v7 offset:61952
    v_mfma_f32_16x16x32_bf16 v[44:47], v[72:75], a[44:47], v[44:47]
    buffer_load_dwordx4 v157, s[32:35], s8 offen offset:1024 lds
    v_mfma_f32_16x16x32_bf16 v[104:107], v[76:79], v[120:123], v[104:107]
    v_mfma_f32_16x16x32_bf16 v[32:35], v[76:79], a[48:51], v[32:35]
    v_mfma_f32_16x16x32_bf16 v[36:39], v[76:79], a[52:55], v[36:39]
    s_nop 0
    v_mfma_f32_16x16x32_bf16 v[40:43], v[76:79], a[56:59], v[40:43]
    s_nop 0
    v_mfma_f32_16x16x32_bf16 v[44:47], v[76:79], a[60:63], v[44:47]
    s_waitcnt vmcnt(6)
    s_barrier
    s_waitcnt lgkmcnt(4)
    v_mfma_f32_16x16x32_bf16 v[104:107], v[80:83], v[120:123], v[104:107]
    s_nop 0
    ds_read_b64_tr_b16 v[64:65], v8 offset:0
    v_mfma_f32_16x16x32_bf16 v[32:35], v[80:83], a[64:67], v[32:35]
    ds_read_b64_tr_b16 v[66:67], v8 offset:512
    v_mfma_f32_16x16x32_bf16 v[36:39], v[80:83], a[68:71], v[36:39]
    s_add_u32 m0, s60, 114688
    s_xor_b32 s8, s72, 131072
    buffer_load_dwordx4 v156, s[32:35], s8 offen offset:0 lds
    v_mfma_f32_16x16x32_bf16 v[40:43], v[80:83], a[72:75], v[40:43]
    v_mfma_f32_16x16x32_bf16 v[44:47], v[80:83], a[76:79], v[44:47]
    ds_read_b64_tr_b16 v[68:69], v8 offset:4096
    v_mfma_f32_16x16x32_bf16 v[104:107], v[84:87], v[120:123], v[104:107]
    ds_read_b64_tr_b16 v[70:71], v8 offset:4608
    v_mfma_f32_16x16x32_bf16 v[32:35], v[84:87], a[80:83], v[32:35]
    buffer_load_dwordx4 v157, s[32:35], s8 offen offset:1024 lds
    v_mfma_f32_16x16x32_bf16 v[36:39], v[84:87], a[84:87], v[36:39]
    v_mfma_f32_16x16x32_bf16 v[40:43], v[84:87], a[88:91], v[40:43]
    ds_read_b64_tr_b16 v[72:73], v8 offset:8192
    v_mfma_f32_16x16x32_bf16 v[44:47], v[84:87], a[92:95], v[44:47]
    s_nop 0
    ds_read_b64_tr_b16 v[74:75], v8 offset:8704
    s_waitcnt lgkmcnt(6)
    v_mfma_f32_16x16x32_bf16 v[104:107], v[88:91], v[120:123], v[104:107]
    ds_read_b64_tr_b16 v[76:77], v8 offset:12288
    v_mfma_f32_16x16x32_bf16 v[32:35], v[88:91], a[96:99], v[32:35]
    v_mfma_f32_16x16x32_bf16 v[36:39], v[88:91], a[100:103], v[36:39]
    s_add_u32 m0, s60, 122880
    s_xor_b32 s8, s72, 196608
    buffer_load_dwordx4 v156, s[32:35], s8 offen offset:0 lds
    v_mfma_f32_16x16x32_bf16 v[40:43], v[88:91], a[104:107], v[40:43]
    ds_read_b64_tr_b16 v[78:79], v8 offset:12800
    v_mfma_f32_16x16x32_bf16 v[44:47], v[88:91], a[108:111], v[44:47]
    buffer_load_dwordx4 v157, s[32:35], s8 offen offset:1024 lds
    v_mfma_f32_16x16x32_bf16 v[104:107], v[92:95], v[120:123], v[104:107]
    v_mfma_f32_16x16x32_bf16 v[32:35], v[92:95], a[112:115], v[32:35]
    v_mfma_f32_16x16x32_bf16 v[36:39], v[92:95], a[116:119], v[36:39]
    s_nop 0
    v_mfma_f32_16x16x32_bf16 v[40:43], v[92:95], a[120:123], v[40:43]
    s_nop 0
    v_mfma_f32_16x16x32_bf16 v[44:47], v[92:95], a[124:127], v[44:47]
    s_waitcnt vmcnt(6)
    s_barrier
    v_mov_b32 v189, 0
    s_add_u32 s56, s9, 98304
    s_mov_b64 exec, 1
    buffer_atomic_add v189, v187, s[48:51], s56 offen sc0
    s_mov_b64 exec, -1
    s_waitcnt lgkmcnt(4)
    v_mfma_f32_16x16x32_bf16 v[104:107], v[64:67], v[120:123], v[104:107]
    ds_read_b64_tr_b16 v[80:81], v8 offset:16384
    v_mfma_f32_16x16x32_bf16 v[32:35], v[64:67], a[128:131], v[32:35]
    s_nop 0
    ds_read_b64_tr_b16 v[82:83], v8 offset:16896
    v_mfma_f32_16x16x32_bf16 v[36:39], v[64:67], a[132:135], v[36:39]
    s_xor_b32 s8, s15, 0
    s_add_u32 m0, s73, 131072
    s_mul_i32 s8, s8, 88064
    buffer_load_dwordx4 v2, s[36:39], s8 offen offset:0 lds
    v_mfma_f32_16x16x32_bf16 v[40:43], v[64:67], a[136:139], v[40:43]
    v_mfma_f32_16x16x32_bf16 v[44:47], v[64:67], a[140:143], v[44:47]
    ds_read_b64_tr_b16 v[84:85], v8 offset:20480
    v_mfma_f32_16x16x32_bf16 v[104:107], v[68:71], v[120:123], v[104:107]
    ds_read_b64_tr_b16 v[86:87], v8 offset:20992
    v_mfma_f32_16x16x32_bf16 v[32:35], v[68:71], a[144:147], v[32:35]
    v_mfma_f32_16x16x32_bf16 v[36:39], v[68:71], a[148:151], v[36:39]
    ds_read_b64_tr_b16 v[88:89], v8 offset:24576
    v_mfma_f32_16x16x32_bf16 v[40:43], v[68:71], a[152:155], v[40:43]
    ds_read_b64_tr_b16 v[90:91], v8 offset:25088
    v_mfma_f32_16x16x32_bf16 v[44:47], v[68:71], a[156:159], v[44:47]
    s_waitcnt lgkmcnt(6)
    v_mfma_f32_16x16x32_bf16 v[104:107], v[72:75], v[120:123], v[104:107]
    s_nop 0
    buffer_load_dwordx4 v3, s[36:39], s8 offen offset:1024 lds
    v_mfma_f32_16x16x32_bf16 v[32:35], v[72:75], a[160:163], v[32:35]
    ds_read_b64_tr_b16 v[92:93], v8 offset:28672
    v_mfma_f32_16x16x32_bf16 v[36:39], v[72:75], a[164:167], v[36:39]
    v_mfma_f32_16x16x32_bf16 v[40:43], v[72:75], a[168:171], v[40:43]
    ds_read_b64_tr_b16 v[94:95], v8 offset:29184
    v_mfma_f32_16x16x32_bf16 v[44:47], v[72:75], a[172:175], v[44:47]
    buffer_load_dwordx4 v4, s[36:39], s8 offen offset:2048 lds
    v_mfma_f32_16x16x32_bf16 v[104:107], v[76:79], v[120:123], v[104:107]
    v_mfma_f32_16x16x32_bf16 v[32:35], v[76:79], a[176:179], v[32:35]
    s_nop 0
    v_mfma_f32_16x16x32_bf16 v[36:39], v[76:79], a[180:183], v[36:39]
    s_nop 0
    v_mfma_f32_16x16x32_bf16 v[40:43], v[76:79], a[184:187], v[40:43]
    v_mfma_f32_16x16x32_bf16 v[44:47], v[76:79], a[188:191], v[44:47]
    s_waitcnt lgkmcnt(4)
    v_mfma_f32_16x16x32_bf16 v[104:107], v[80:83], v[120:123], v[104:107]
    s_xor_b32 s8, s15, 1
    s_add_u32 m0, s73, 143360
    s_mul_i32 s8, s8, 88064
    buffer_load_dwordx4 v2, s[36:39], s8 offen offset:0 lds
    v_mfma_f32_16x16x32_bf16 v[32:35], v[80:83], a[192:195], v[32:35]
    v_mfma_f32_16x16x32_bf16 v[36:39], v[80:83], a[196:199], v[36:39]
    v_mfma_f32_16x16x32_bf16 v[40:43], v[80:83], a[200:203], v[40:43]
    v_mfma_f32_16x16x32_bf16 v[44:47], v[80:83], a[204:207], v[44:47]
    v_mfma_f32_16x16x32_bf16 v[104:107], v[84:87], v[120:123], v[104:107]
    buffer_load_dwordx4 v3, s[36:39], s8 offen offset:1024 lds
    v_mfma_f32_16x16x32_bf16 v[32:35], v[84:87], a[208:211], v[32:35]
    v_mfma_f32_16x16x32_bf16 v[36:39], v[84:87], a[212:215], v[36:39]
    v_mfma_f32_16x16x32_bf16 v[40:43], v[84:87], a[216:219], v[40:43]
    s_nop 0
    v_mfma_f32_16x16x32_bf16 v[44:47], v[84:87], a[220:223], v[44:47]
    s_waitcnt lgkmcnt(0)
    v_mfma_f32_16x16x32_bf16 v[104:107], v[88:91], v[120:123], v[104:107]
    buffer_load_dwordx4 v4, s[36:39], s8 offen offset:2048 lds
    v_mfma_f32_16x16x32_bf16 v[32:35], v[88:91], a[224:227], v[32:35]
    v_mfma_f32_16x16x32_bf16 v[36:39], v[88:91], a[228:231], v[36:39]
    v_mfma_f32_16x16x32_bf16 v[40:43], v[88:91], a[232:235], v[40:43]
    v_mfma_f32_16x16x32_bf16 v[44:47], v[88:91], a[236:239], v[44:47]
    v_mfma_f32_16x16x32_bf16 v[104:107], v[92:95], v[120:123], v[104:107]
    v_mfma_f32_16x16x32_bf16 v[32:35], v[92:95], a[240:243], v[32:35]
    v_mfma_f32_16x16x32_bf16 v[36:39], v[92:95], a[244:247], v[36:39]
    v_mfma_f32_16x16x32_bf16 v[40:43], v[92:95], a[248:251], v[40:43]
    s_nop 0
    v_mfma_f32_16x16x32_bf16 v[44:47], v[92:95], a[252:255], v[44:47]
    s_waitcnt vmcnt(6)
    v_readfirstlane_b32 s56, v189
    s_nop 0
    s_cmp_eq_u32 s56, 4
    s_cbranch_scc0 L_again_8
L_ok_7:
    buffer_load_dwordx4 v[208:211], v11, s[48:51], s18 offen sc1
    buffer_load_dwordx4 v[192:195], v1, s[48:51], s18 offen offset:0 sc1
    buffer_load_dwordx4 v[196:199], v1, s[48:51], s18 offen offset:1152 sc1
    buffer_load_dwordx4 v[200:203], v1, s[48:51], s18 offen offset:2304 sc1
    buffer_load_dwordx4 v[204:207], v1, s[48:51], s18 offen offset:3456 sc1
    s_branch L_join_6
L_red_5:
    s_xor_b32 s6, s6, s12
    s_xor_b32 s17, s17, s12
    s_mov_b32 s1, 0
    s_atomic_add s1, s[22:23], s6 offset:114688 glc
    s_lshr_b32 s24, s72, 2
    s_xor_b32 s18, s18, s12
    v_mov_b32_e64 v187, 0
    s_xor_b32 s61, s61, s12
    s_and_b32 s13, s61, 0x2000
    s_and_b32 s57, s54, 1
    s_lshl2_add_u32 s25, s53, s57
    s_lshl_b32 s25, s25, 7
    s_xor_b32 s25, s25, s12
    s_lshr_b32 s58, s52, 1
    s_bfe_u32 s56, s11, 0x10002
    s_lshl1_add_u32 s21, s10, s56
    s_xor_b32 s14, s21, s58
    s_xor_b32 s14, s14, 1
    s_and_b32 s57, s52, 1
    s_lshl2_add_u32 s26, s14, s57
    s_and_b32 s56, s11, 3
    s_lshl2_add_u32 s27, s21, s56
    s_lshl_b32 s26, s26, 7
    s_lshl_b32 s27, s27, 7
    s_xor_b32 s26, s26, s12
    s_xor_b32 s27, s27, s12
    s_lshl_b32 s20, s58, 15
    s_lshl_b32 s56, s57, 12
    s_add_u32 s20, s20, s56
    s_lshl_b32 s57, s57, 8
    s_lshl_b32 s58, s58, 10
    s_or_b32 s57, s57, s58
    v_xor_b32 v13, s57, v1
    v_xor_b32 v14, 1024, v13
    v_lshlrev_b32_e64 v16, 16, v240
    v_and_b32 v17, 0xffff0000, v240
    v_lshlrev_b32_e64 v18, 16, v241
    v_and_b32 v19, 0xffff0000, v241
    v_lshlrev_b32_e64 v20, 16, v242
    v_and_b32 v21, 0xffff0000, v242
    v_lshlrev_b32_e64 v22, 16, v243
    v_and_b32 v23, 0xffff0000, v243
    v_lshlrev_b32_e64 v24, 16, v244
    v_and_b32 v25, 0xffff0000, v244
    v_lshlrev_b32_e64 v26, 16, v245
    v_and_b32 v27, 0xffff0000, v245
    v_lshlrev_b32_e64 v28, 16, v246
    v_and_b32 v29, 0xffff0000, v246
    v_lshlrev_b32_e64 v30, 16, v247
    v_and_b32 v31, 0xffff0000, v247
    v_and_b32 v116, 15, v10
    v_cmp_eq_u32 vcc, 0, v116
    s_nop 1
    v_cndmask_b32 v116, 0, v120, vcc
    v_mov_b32 v117, v116
    v_mov_b32 v118, v116
    v_mov_b32_e64 v119, v116
    s_and_b32 s56, s53, 15
    s_lshl_b32 s56, s56, 17
    s_add_u32 s56, s56, s60
    s_xor_b32 s57, s13, 2105344
    s_add_u32 s16, s56, s57
    s_lshl_b32 s57, s54, 14
    s_add_u32 s59, s16, s57
    v_mov_b32 v128, 0x3fb8aa3b
    v_mov_b32_e64 v129, v15
    s_add_u32 m0, s60, 40960
    s_add_u32 s8, s65, 0
    buffer_load_dwordx4 v154, s[28:31], s8 offen offset:0 lds
    buffer_load_dwordx4 v155, s[28:31], s8 offen offset:1024 lds
    s_add_u32 m0, s60, 49152
    s_add_u32 s8, s66, 0
    buffer_load_dwordx4 v154, s[28:31], s8 offen offset:0 lds
    buffer_load_dwordx4 v155, s[28:31], s8 offen offset:1024 lds
    s_add_u32 m0, s60, 57344
    s_add_u32 s8, s67, 0
    buffer_load_dwordx4 v154, s[28:31], s8 offen offset:0 lds
    buffer_load_dwordx4 v155, s[28:31], s8 offen offset:1024 lds
    s_add_u32 m0, s60, 65536
    s_add_u32 s8, s68, 0
    buffer_load_dwordx4 v154, s[28:31], s8 offen offset:0 lds
    buffer_load_dwordx4 v155, s[28:31], s8 offen offset:1024 lds
    s_add_u32 m0, s60, 73728
    s_add_u32 s8, s69, 0
    buffer_load_dwordx4 v154, s[28:31], s8 offen offset:0 lds
    buffer_load_dwordx4 v155, s[28:31], s8 offen offset:1024 lds
    s_waitcnt lgkmcnt(0)
    s_cmp_eq_u32 s1, 8
    s_cbranch_scc0 L_slow_10
L_ok_9:
    buffer_load_dwordx4 v[224:227], v185, s[48:51], s17 offen sc1
    buffer_load_dwordx4 v[192:195], v1, s[48:51], s17 offen offset:0 sc1
    buffer_load_dwordx4 v[196:199], v1, s[48:51], s17 offen offset:1152 sc1
    buffer_load_dwordx4 v[200:203], v1, s[48:51], s17 offen offset:2304 sc1
    buffer_load_dwordx4 v[204:207], v1, s[48:51], s17 offen offset:3456 sc1
    s_add_u32 s58, s17, 16384
    buffer_load_dwordx4 v[208:211], v1, s[48:51], s58 offen offset:0 sc1
    buffer_load_dwordx4 v[212:215], v1, s[48:51], s58 offen offset:1152 sc1
    buffer_load_dwordx4 v[216:219], v1, s[48:51], s58 offen offset:2304 sc1
    buffer_load_dwordx4 v[220:223], v1, s[48:51], s58 offen offset:3456 sc1
    s_mov_b64 exec, 15
    buffer_atomic_add v188, v190, s[48:51], 0 offen
    s_mov_b64 exec, -1
    s_waitcnt vmcnt(18)
    s_barrier
    ds_read_b64_tr_b16 v[64:65], v7 offset:32768
    ds_read_b64_tr_b16 v[66:67], v7 offset:33280
    ds_read_b64_tr_b16 v[68:69], v7 offset:36864
    s_add_u32 m0, s60, 81920
    s_add_u32 s8, s70, 0
    s_nop 0
    buffer_load_dwordx4 v154, s[28:31], s8 offen offset:0 lds
    ds_read_b64_tr_b16 v[70:71], v7 offset:37376
    ds_read_b64_tr_b16 v[72:73], v7 offset:40960
    ds_read_b64_tr_b16 v[74:75], v7 offset:41472
    ds_read_b64_tr_b16 v[76:77], v7 offset:45056
    ds_read_b64_tr_b16 v[78:79], v7 offset:45568
    buffer_load_dwordx4 v155, s[28:31], s8 offen offset:1024 lds
    s_waitcnt vmcnt(16)
    s_barrier
    s_waitcnt lgkmcnt(4)
    v_mfma_f32_16x16x32_bf16 v[104:107], v[64:67], v[120:123], 0
    s_nop 0
    ds_read_b64_tr_b16 v[80:81], v7 offset:49152
    v_mfma_f32_16x16x32_bf16 v[32:35], v[64:67], a[0:3], 0
    s_nop 0
    ds_read_b64_tr_b16 v[82:83], v7 offset:49664
    v_mfma_f32_16x16x32_bf16 v[36:39], v[64:67], a[4:7], 0
    s_add_u32 m0, s60, 90112
    s_add_u32 s8, s71, 0
    buffer_load_dwordx4 v154, s[28:31], s8 offen offset:0 lds
    v_mfma_f32_16x16x32_bf16 v[40:43], v[64:67], a[8:11], 0
    v_mfma_f32_16x16x32_bf16 v[44:47], v[64:67], a[12:15], 0
    ds_read_b64_tr_b16 v[84:85], v7 offset:53248
    v_mfma_f32_16x16x32_bf16 v[104:107], v[68:71], v[120:123], v[104:107]
    ds_read_b64_tr_b16 v[86:87], v7 offset:53760
    v_mfma_f32_16x16x32_bf16 v[32:35], v[68:71], a[16:19], v[32:35]
    buffer_load_dwordx4 v155, s[28:31], s8 offen offset:1024 lds
    v_mfma_f32_16x16x32_bf16 v[36:39], v[68:71], a[20:23], v[36:39]
    v_mfma_f32_16x16x32_bf16 v[40:43], v[68:71], a[24:27], v[40:43]
    ds_read_b64_tr_b16 v[88:89], v7 offset:57344
    v_mfma_f32_16x16x32_bf16 v[44:47], v[68:71], a[28:31], v[44:47]
    s_nop 0
    ds_read_b64_tr_b16 v[90:91], v7 offset:57856
    s_waitcnt lgkmcnt(6)
    v_mfma_f32_16x16x32_bf16 v[104:107], v[72:75], v[120:123], v[104:107]
    ds_read_b64_tr_b16 v[92:93], v7 offset:61440
    v_mfma_f32_16x16x32_bf16 v[32:35], v[72:75], a[32:35], v[32:35]
    v_mfma_f32_16x16x32_bf16 v[36:39], v[72:75], a[36:39], v[36:39]
    s_add_u32 m0, s60, 106496
    s_xor_b32 s8, s72, 65536
    buffer_load_dwordx4 v156, s[32:35], s8 offen offset:0 lds
    v_mfma_f32_16x16x32_bf16 v[40:43], v[72:75], a[40:43], v[40:43]
    ds_read_b64_tr_b16 v[94:95], v7 offset:61952
    v_mfma_f32_16x16x32_bf16 v[44:47], v[72:75], a[44:47], v[44:47]
    buffer_load_dwordx4 v157, s[32:35], s8 offen offset:1024 lds
    v_mfma_f32_16x16x32_bf16 v[104:107], v[76:79], v[120:123], v[104:107]
    s_nop 0
    v_mfma_f32_16x16x32_bf16 v[32:35], v[76:79], a[48:51], v[32:35]
    s_nop 0
    v_mfma_f32_16x16x32_bf16 v[36:39], v[76:79], a[52:55], v[36:39]
    v_mfma_f32_16x16x32_bf16 v[40:43], v[76:79], a[56:59], v[40:43]
    s_nop 0
    v_mfma_f32_16x16x32_bf16 v[44:47], v[76:79], a[60:63], v[44:47]
    s_waitcnt vmcnt(16)
    s_barrier
L_again_12:
    s_waitcnt vmcnt(15)
    v_add_f32_dpp v100, v224, v224 quad_perm:[1,0,3,2] row_mask:0xf bank_mask:0xf
    v_add_f32_dpp v101, v225, v225 quad_perm:[1,0,3,2] row_mask:0xf bank_mask:0xf
    v_add_f32_dpp v102, v226, v226 quad_perm:[1,0,3,2] row_mask:0xf bank_mask:0xf
    v_add_f32_dpp v103, v227, v227 quad_perm:[1,0,3,2] row_mask:0xf bank_mask:0xf
    v_add_f32_dpp v100, v100, v100 quad_perm:[2,3,0,1] row_mask:0xf bank_mask:0xf
    v_add_f32_dpp v101, v101, v101 quad_perm:[2,3,0,1] row_mask:0xf bank_mask:0xf
    v_add_f32_dpp v102, v102, v102 quad_perm:[2,3,0,1] row_mask:0xf bank_mask:0xf
    v_add_f32_dpp v103, v103, v103 quad_perm:[2,3,0,1] row_mask:0xf bank_mask:0xf
    v_add_f32_dpp v100, v100, v100 row_half_mirror row_mask:0xf bank_mask:0xf
    v_add_f32_dpp v101, v101, v101 row_half_mirror row_mask:0xf bank_mask:0xf
    v_add_f32_dpp v102, v102, v102 row_half_mirror row_mask:0xf bank_mask:0xf
    v_add_f32_dpp v103, v103, v103 row_half_mirror row_mask:0xf bank_mask:0xf
    s_waitcnt vmcnt(13)
    v_pk_add_f32 v[96:97], v[192:193], v[196:197]
    v_pk_add_f32 v[98:99], v[194:195], v[198:199]
    s_waitcnt vmcnt(12)
    v_pk_add_f32 v[96:97], v[96:97], v[200:201]
    v_pk_add_f32 v[98:99], v[98:99], v[202:203]
    s_waitcnt vmcnt(11)
    v_pk_add_f32 v[96:97], v[96:97], v[204:205]
    v_pk_add_f32 v[98:99], v[98:99], v[206:207]
    s_waitcnt vmcnt(10)
    v_pk_add_f32 v[96:97], v[96:97], v[208:209]
    v_pk_add_f32 v[98:99], v[98:99], v[210:211]
    s_waitcnt vmcnt(9)
    v_pk_add_f32 v[96:97], v[96:97], v[212:213]
    v_pk_add_f32 v[98:99], v[98:99], v[214:215]
    s_waitcnt vmcnt(8)
    v_pk_add_f32 v[96:97], v[96:97], v[216:217]
    v_pk_add_f32 v[98:99], v[98:99], v[218:219]
    s_waitcnt vmcnt(7)
    s_nop 0
    v_pk_add_f32 v[96:97], v[96:97], v[220:221]
    v_pk_add_f32 v[98:99], v[98:99], v[222:223]
    v_pk_add_f32 v[228:229], v[96:97], v[98:99]
    v_pk_add_f32 v[230:231], v[100:101], v[102:103]
    v_pk_add_f32 v[228:229], v[228:229], v[230:231]
    v_cmp_u_f32 vcc, v228, v229
    s_nop 0
    s_cbranch_vccnz L_ok_13_s
L_ok_13:
    s_xor_b32 s56, s19, s13
    s_xor_b32 s57, s56, 0x2000
    v_min_u32 v96, -2, v96
    v_min_u32 v97, -2, v97
    v_min_u32 v98, -2, v98
    v_min_u32 v99, -2, v99
    v_min_u32 v100, -2, v100
    v_min_u32 v101, -2, v101
    v_min_u32_e64 v102, -2, v102
    v_min_u32_e64 v103, -2, v103
    buffer_store_dwordx4 v[96:99], v1, s[48:51], s57 offen sc1
    buffer_store_dwordx4 v[100:103], v12, s[48:51], s57 offen sc1
    buffer_store_dwordx4 v[96:99], v1, s[48:51], s56 offen sc1
    buffer_store_dwordx4 v[100:103], v12, s[48:51], s56 offen sc1
    s_waitcnt lgkmcnt(4)
    v_mfma_f32_16x16x32_bf16 v[104:107], v[80:83], v[120:123], v[104:107]
    s_nop 0
    ds_read_b64_tr_b16 v[64:65], v8 offset:0
    v_mfma_f32_16x16x32_bf16 v[32:35], v[80:83], a[64:67], v[32:35]
    ds_read_b64_tr_b16 v[66:67], v8 offset:512
    v_mfma_f32_16x16x32_bf16 v[36:39], v[80:83], a[68:71], v[36:39]
    s_add_u32 m0, s60, 114688
    s_xor_b32 s8, s72, 131072
    buffer_load_dwordx4 v156, s[32:35], s8 offen offset:0 lds
    v_mfma_f32_16x16x32_bf16 v[40:43], v[80:83], a[72:75], v[40:43]
    v_mfma_f32_16x16x32_bf16 v[44:47], v[80:83], a[76:79], v[44:47]
    ds_read_b64_tr_b16 v[68:69], v8 offset:4096
    v_mfma_f32_16x16x32_bf16 v[104:107], v[84:87], v[120:123], v[104:107]
    ds_read_b64_tr_b16 v[70:71], v8 offset:4608
    v_mfma_f32_16x16x32_bf16 v[32:35], v[84:87], a[80:83], v[32:35]
    buffer_load_dwordx4 v157, s[32:35], s8 offen offset:1024 lds
    v_mfma_f32_16x16x32_bf16 v[36:39], v[84:87], a[84:87], v[36:39]
    v_mfma_f32_16x16x32_bf16 v[40:43], v[84:87], a[88:91], v[40:43]
    ds_read_b64_tr_b16 v[72:73], v8 offset:8192
    v_mfma_f32_16x16x32_bf16 v[44:47], v[84:87], a[92:95], v[44:47]
    s_nop 0
    ds_read_b64_tr_b16 v[74:75], v8 offset:8704
    s_waitcnt lgkmcnt(6)
    v_mfma_f32_16x16x32_bf16 v[104:107], v[88:91], v[120:123], v[104:107]
    ds_read_b64_tr_b16 v[76:77], v8 offset:12288
    v_mfma_f32_16x16x32_bf16 v[32:35], v[88:91], a[96:99], v[32:35]
    v_mfma_f32_16x16x32_bf16 v[36:39], v[88:91], a[100:103], v[36:39]
    s_add_u32 m0, s60, 122880
    s_xor_b32 s8, s72, 196608
    buffer_load_dwordx4 v156, s[32:35], s8 offen offset:0 lds
    v_mfma_f32_16x16x32_bf16 v[40:43], v[88:91], a[104:107], v[40:43]
    ds_read_b64_tr_b16 v[78:79], v8 offset:12800
    v_mfma_f32_16x16x32_bf16 v[44:47], v[88:91], a[108:111], v[44:47]
    buffer_load_dwordx4 v157, s[32:35], s8 offen offset:1024 lds
    v_mfma_f32_16x16x32_bf16 v[104:107], v[92:95], v[120:123], v[104:107]
    v_mfma_f32_16x16x32_bf16 v[32:35], v[92:95], a[112:115], v[32:35]
    v_mfma_f32_16x16x32_bf16 v[36:39], v[92:95], a[116:119], v[36:39]
    s_nop 0
    v_mfma_f32_16x16x32_bf16 v[40:43], v[92:95], a[120:123], v[40:43]
    s_nop 0
    v_mfma_f32_16x16x32_bf16 v[44:47], v[92:95], a[124:127], v[44:47]
    s_waitcnt vmcnt(10)
    s_barrier
    v_mov_b32 v189, 0
    s_add_u32 s56, s9, 98304
    s_mov_b64 exec, 1
    buffer_atomic_add v189, v187, s[48:51], s56 offen sc0
    s_mov_b64 exec, -1
    s_waitcnt lgkmcnt(4)
    v_mfma_f32_16x16x32_bf16 v[104:107], v[64:67], v[120:123], v[104:107]
    ds_read_b64_tr_b16 v[80:81], v8 offset:16384
    v_mfma_f32_16x16x32_bf16 v[32:35], v[64:67], a[128:131], v[32:35]
    s_nop 0
    ds_read_b64_tr_b16 v[82:83], v8 offset:16896
    v_mfma_f32_16x16x32_bf16 v[36:39], v[64:67], a[132:135], v[36:39]
    s_xor_b32 s8, s15, 0
    s_add_u32 m0, s73, 131072
    s_mul_i32 s8, s8, 88064
    buffer_load_dwordx4 v2, s[36:39], s8 offen offset:0 lds
    v_mfma_f32_16x16x32_bf16 v[40:43], v[64:67], a[136:139], v[40:43]
    v_mfma_f32_16x16x32_bf16 v[44:47], v[64:67], a[140:143], v[44:47]
    ds_read_b64_tr_b16 v[84:85], v8 offset:20480
    v_mfma_f32_16x16x32_bf16 v[104:107], v[68:71], v[120:123], v[104:107]
    ds_read_b64_tr_b16 v[86:87], v8 offset:20992
    v_mfma_f32_16x16x32_bf16 v[32:35], v[68:71], a[144:147], v[32:35]
    v_mfma_f32_16x16x32_bf16 v[36:39], v[68:71], a[148:151], v[36:39]
    ds_read_b64_tr_b16 v[88:89], v8 offset:24576
    v_mfma_f32_16x16x32_bf16 v[40:43], v[68:71], a[152:155], v[40:43]
    ds_read_b64_tr_b16 v[90:91], v8 offset:25088
    v_mfma_f32_16x16x32_bf16 v[44:47], v[68:71], a[156:159], v[44:47]
    s_waitcnt lgkmcnt(6)
    v_mfma_f32_16x16x32_bf16 v[104:107], v[72:75], v[120:123], v[104:107]
    s_nop 0
    buffer_load_dwordx4 v3, s[36:39], s8 offen offset:1024 lds
    v_mfma_f32_16x16x32_bf16 v[32:35], v[72:75], a[160:163], v[32:35]
    ds_read_b64_tr_b16 v[92:93], v8 offset:28672
    v_mfma_f32_16x16x32_bf16 v[36:39], v[72:75], a[164:167], v[36:39]
    v_mfma_f32_16x16x32_bf16 v[40:43], v[72:75], a[168:171], v[40:43]
    ds_read_b64_tr_b16 v[94:95], v8 offset:29184
    v_mfma_f32_16x16x32_bf16 v[44:47], v[72:75], a[172:175], v[44:47]
    buffer_load_dwordx4 v4, s[36:39], s8 offen offset:2048 lds
    v_mfma_f32_16x16x32_bf16 v[104:107], v[76:79], v[120:123], v[104:107]
    v_mfma_f32_16x16x32_bf16 v[32:35], v[76:79], a[176:179], v[32:35]
    s_nop 0
    v_mfma_f32_16x16x32_bf16 v[36:39], v[76:79], a[180:183], v[36:39]
    s_nop 0
    v_mfma_f32_16x16x32_bf16 v[40:43], v[76:79], a[184:187], v[40:43]
    v_mfma_f32_16x16x32_bf16 v[44:47], v[76:79], a[188:191], v[44:47]
    s_waitcnt lgkmcnt(4)
    v_mfma_f32_16x16x32_bf16 v[104:107], v[80:83], v[120:123], v[104:107]
    s_xor_b32 s8, s15, 1
    s_add_u32 m0, s73, 143360
    s_mul_i32 s8, s8, 88064
    buffer_load_dwordx4 v2, s[36:39], s8 offen offset:0 lds
    v_mfma_f32_16x16x32_bf16 v[32:35], v[80:83], a[192:195], v[32:35]
    v_mfma_f32_16x16x32_bf16 v[36:39], v[80:83], a[196:199], v[36:39]
    v_mfma_f32_16x16x32_bf16 v[40:43], v[80:83], a[200:203], v[40:43]
    v_mfma_f32_16x16x32_bf16 v[44:47], v[80:83], a[204:207], v[44:47]
    v_mfma_f32_16x16x32_bf16 v[104:107], v[84:87], v[120:123], v[104:107]
    buffer_load_dwordx4 v3, s[36:39], s8 offen offset:1024 lds
    v_mfma_f32_16x16x32_bf16 v[32:35], v[84:87], a[208:211], v[32:35]
    v_mfma_f32_16x16x32_bf16 v[36:39], v[84:87], a[212:215], v[36:39]
    v_mfma_f32_16x16x32_bf16 v[40:43], v[84:87], a[216:219], v[40:43]
    s_nop 0
    v_mfma_f32_16x16x32_bf16 v[44:47], v[84:87], a[220:223], v[44:47]
    s_waitcnt lgkmcnt(0)
    v_mfma_f32_16x16x32_bf16 v[104:107], v[88:91], v[120:123], v[104:107]
    buffer_load_dwordx4 v4, s[36:39], s8 offen offset:2048 lds
    v_mfma_f32_16x16x32_bf16 v[32:35], v[88:91], a[224:227], v[32:35]
    v_mfma_f32_16x16x32_bf16 v[36:39], v[88:91], a[228:231], v[36:39]
    v_mfma_f32_16x16x32_bf16 v[40:43], v[88:91], a[232:235], v[40:43]
    v_mfma_f32_16x16x32_bf16 v[44:47], v[88:91], a[236:239], v[44:47]
    v_mfma_f32_16x16x32_bf16 v[104:107], v[92:95], v[120:123], v[104:107]
    v_mfma_f32_16x16x32_bf16 v[32:35], v[92:95], a[240:243], v[32:35]
    v_mfma_f32_16x16x32_bf16 v[36:39], v[92:95], a[244:247], v[36:39]
    v_mfma_f32_16x16x32_bf16 v[40:43], v[92:95], a[248:251], v[40:43]
    s_nop 0
    v_mfma_f32_16x16x32_bf16 v[44:47], v[92:95], a[252:255], v[44:47]
    s_waitcnt vmcnt(6)
    v_readfirstlane_b32 s56, v189
    s_nop 0
    s_cmp_eq_u32 s56, 4
    s_cbranch_scc0 L_again_15
L_ok_14:
    buffer_load_dwordx4 v[208:211], v11, s[48:51], s18 offen sc1
    buffer_load_dwordx4 v[192:195], v1, s[48:51], s18 offen offset:0 sc1
    buffer_load_dwordx4 v[196:199], v1, s[48:51], s18 offen offset:1152 sc1
    buffer_load_dwordx4 v[200:203], v1, s[48:51], s18 offen offset:2304 sc1
    buffer_load_dwordx4 v[204:207], v1, s[48:51], s18 offen offset:3456 sc1
L_join_6:
    s_nop 0
    s_barrier
    s_add_u32 m0, s60, 65536
    s_xor_b32 s8, s72, 262144
    buffer_load_dwordx4 v156, s[32:35], s8 offen offset:0 lds
    buffer_load_dwordx4 v157, s[32:35], s8 offen offset:1024 lds
    v_pk_fma_f32 v[32:33], v[104:105], v[248:249], v[32:33] op_sel_hi:[1,0,1]
    v_pk_fma_f32 v[32:33], v[32:33], v[248:249], v[124:125] op_sel:[0,1,0]
    v_pk_fma_f32 v[136:137], v[32:33], v[128:129], v[128:129] op_sel:[0,0,1] op_sel_hi:[1,0,1]
    v_exp_f32_e64 v136, v136 clamp
    v_exp_f32_e64 v137, v137 clamp
L_pad2:
    s_cbranch_execz L_pad3
    v_max_f32 v32, v32, v124
    v_max_f32_e64 v33, v33, v124
    v_pk_add_f32 v[32:33], v[32:33], v[136:137]
    v_cvt_pk_bf16_f32 v108, v32, v33
    v_pk_fma_f32 v[34:35], v[106:107], v[248:249], v[34:35] op_sel_hi:[1,0,1]
    v_pk_fma_f32 v[34:35], v[34:35], v[248:249], v[124:125] op_sel:[0,1,0]
    v_pk_fma_f32 v[138:139], v[34:35], v[128:129], v[128:129] op_sel:[0,0,1] op_sel_hi:[1,0,1]
    v_exp_f32_e64 v138, v138 clamp
    s_add_u32 m0, s60, 73728
    s_xor_b32 s8, s72, 327680
    buffer_load_dwordx4 v156, s[32:35], s8 offen offset:0 lds
    v_exp_f32_e64 v139, v139 clamp
    v_max_f32 v34, v34, v124
    v_max_f32 v35, v35, v124
    v_pk_add_f32 v[34:35], v[34:35], v[138:139]
    v_cvt_pk_bf16_f32 v109, v34, v35
    v_pk_fma_f32 v[36:37], v[104:105], v[250:251], v[36:37] op_sel_hi:[1,0,1]
    v_pk_fma_f32 v[36:37], v[36:37], v[250:251], v[124:125] op_sel:[0,1,0]
    v_pk_fma_f32 v[140:141], v[36:37], v[128:129], v[128:129] op_sel:[0,0,1] op_sel_hi:[1,0,1]
    v_exp_f32_e64 v140, v140 clamp
    v_exp_f32_e64 v141, v141 clamp
    v_max_f32 v36, v36, v124
    v_max_f32 v37, v37, v124
    v_pk_add_f32 v[36:37], v[36:37], v[140:141]
    v_cvt_pk_bf16_f32 v110, v36, v37
    v_pk_fma_f32 v[38:39], v[106:107], v[250:251], v[38:39] op_sel_hi:[1,0,1]
    v_pk_fma_f32 v[38:39], v[38:39], v[250:251], v[124:125] op_sel:[0,1,0]
    v_pk_fma_f32 v[142:143], v[38:39], v[128:129], v[128:129] op_sel:[0,0,1] op_sel_hi:[1,0,1]
    v_exp_f32_e64 v142, v142 clamp
    v_exp_f32_e64 v143, v143 clamp
    v_max_f32 v38, v38, v124
    v_max_f32 v39, v39, v124
    buffer_load_dwordx4 v157, s[32:35], s8 offen offset:1024 lds
    v_pk_add_f32 v[38:39], v[38:39], v[142:143]
    v_cvt_pk_bf16_f32 v111, v38, v39
    v_pk_fma_f32 v[40:41], v[104:105], v[252:253], v[40:41] op_sel_hi:[1,0,1]
    v_pk_fma_f32 v[40:41], v[40:41], v[252:253], v[124:125] op_sel:[0,1,0]
    v_pk_fma_f32 v[144:145], v[40:41], v[128:129], v[128:129] op_sel:[0,0,1] op_sel_hi:[1,0,1]
    v_exp_f32_e64 v144, v144 clamp
    v_exp_f32_e64 v145, v145 clamp
    v_max_f32 v40, v40, v124
    v_max_f32 v41, v41, v124
    v_pk_add_f32 v[40:41], v[40:41], v[144:145]
    v_cvt_pk_bf16_f32 v112, v40, v41
    v_pk_fma_f32 v[42:43], v[106:107], v[252:253], v[42:43] op_sel_hi:[1,0,1]
    v_pk_fma_f32 v[42:43], v[42:43], v[252:253], v[124:125] op_sel:[0,1,0]
    v_pk_fma_f32 v[146:147], v[42:43], v[128:129], v[128:129] op_sel:[0,0,1] op_sel_hi:[1,0,1]
    v_exp_f32_e64 v146, v146 clamp
    v_exp_f32_e64 v147, v147 clamp
    v_max_f32 v42, v42, v124
    v_max_f32 v43, v43, v124
    v_pk_add_f32 v[42:43], v[42:43], v[146:147]
    v_cvt_pk_bf16_f32 v113, v42, v43
    v_pk_fma_f32 v[44:45], v[104:105], v[254:255], v[44:45] op_sel_hi:[1,0,1]
    s_add_u32 m0, s60, 81920
    s_xor_b32 s8, s72, 393216
    buffer_load_dwordx4 v156, s[32:35], s8 offen offset:0 lds
    v_pk_fma_f32 v[44:45], v[44:45], v[254:255], v[124:125] op_sel:[0,1,0]
    v_pk_fma_f32 v[148:149], v[44:45], v[128:129], v[128:129] op_sel:[0,0,1] op_sel_hi:[1,0,1]
    v_exp_f32_e64 v148, v148 clamp
    v_exp_f32_e64 v149, v149 clamp
    v_max_f32 v44, v44, v124
    v_max_f32 v45, v45, v124
    v_pk_add_f32 v[44:45], v[44:45], v[148:149]
    v_cvt_pk_bf16_f32 v114, v44, v45
    v_pk_fma_f32 v[46:47], v[106:107], v[254:255], v[46:47] op_sel_hi:[1,0,1]
    v_pk_fma_f32 v[46:47], v[46:47], v[254:255], v[124:125] op_sel:[0,1,0]
    v_pk_fma_f32 v[150:151], v[46:47], v[128:129], v[128:129] op_sel:[0,0,1] op_sel_hi:[1,0,1]
    v_exp_f32_e64 v150, v150 clamp
    v_exp_f32_e64 v151, v151 clamp
    v_max_f32 v46, v46, v124
    v_max_f32 v47, v47, v124
    v_pk_add_f32 v[46:47], v[46:47], v[150:151]
    v_cvt_pk_bf16_f32 v115, v46, v47
L_again_16:
    s_waitcnt vmcnt(5)
    v_add_f32_dpp v92, v208, v208 quad_perm:[1,0,3,2] row_mask:0xf bank_mask:0xf
    s_waitcnt vmcnt(5)
    v_add_f32_dpp v93, v209, v209 quad_perm:[1,0,3,2] row_mask:0xf bank_mask:0xf
    s_waitcnt vmcnt(5)
    v_add_f32_dpp v94, v210, v210 quad_perm:[1,0,3,2] row_mask:0xf bank_mask:0xf
    s_waitcnt vmcnt(5)
    v_add_f32_dpp v95, v211, v211 quad_perm:[1,0,3,2] row_mask:0xf bank_mask:0xf
    v_add_f32_dpp v92, v92, v92 quad_perm:[2,3,0,1] row_mask:0xf bank_mask:0xf
    v_add_f32_dpp v93, v93, v93 quad_perm:[2,3,0,1] row_mask:0xf bank_mask:0xf
    v_add_f32_dpp v94, v94, v94 quad_perm:[2,3,0,1] row_mask:0xf bank_mask:0xf
    v_add_f32_dpp v95, v95, v95 quad_perm:[2,3,0,1] row_mask:0xf bank_mask:0xf
    s_waitcnt vmcnt(5)
    v_pk_add_f32 v[88:89], v[192:193], v[196:197]
    s_waitcnt vmcnt(5)
    v_pk_add_f32 v[90:91], v[194:195], v[198:199]
    s_waitcnt vmcnt(5)
    v_pk_add_f32 v[88:89], v[88:89], v[200:201]
    s_waitcnt vmcnt(5)
    v_pk_add_f32 v[90:91], v[90:91], v[202:203]
    s_waitcnt vmcnt(5)
    v_pk_add_f32 v[88:89], v[88:89], v[204:205]
    s_waitcnt vmcnt(5)
    v_pk_add_f32 v[90:91], v[90:91], v[206:207]
    v_pk_add_f32 v[212:213], v[88:89], v[90:91]
    v_pk_add_f32 v[214:215], v[92:93], v[94:95]
    v_pk_add_f32 v[212:213], v[212:213], v[214:215]
    v_cmp_u_f32 vcc, v212, v213
    s_nop 0
    s_nop 0
    s_cbranch_vccnz L_ok_17_s
L_ok_17:
    v_cvt_pk_bf16_f32 v122, v92, v93
    v_cvt_pk_bf16_f32 v123, v94, v95
    v_cvt_pk_bf16_f32 v120, v88, v89
    v_cvt_pk_bf16_f32 v121, v90, v91
    v_mfma_f32_16x16x16_bf16 v[64:67], v[122:123], v[108:109], v[124:127]
    v_mfma_f32_16x16x16_bf16 v[68:71], v[122:123], v[110:111], v[124:127]
    v_mfma_f32_16x16x16_bf16 v[72:75], v[122:123], v[112:113], v[124:127]
    v_mfma_f32_16x16x16_bf16 v[76:79], v[122:123], v[114:115], v[124:127]
    v_mfma_f32_16x16x16_bf16 v[48:51], v[120:121], v[108:109], 0
    buffer_load_dwordx4 v157, s[32:35], s8 offen offset:1024 lds
    v_mfma_f32_16x16x16_bf16 v[52:55], v[120:121], v[110:111], 0
    v_mfma_f32_16x16x16_bf16 v[56:59], v[120:121], v[112:113], 0
    v_mfma_f32_16x16x16_bf16 v[60:63], v[120:121], v[114:115], 0
    v_rcp_f32 v64, v64
    v_rcp_f32 v68, v68
    v_rcp_f32 v72, v72
    v_rcp_f32 v76, v76
    v_pk_mul_f32 v[48:49], v[48:49], v[64:65] op_sel_hi:[1,0]
    v_cvt_pk_bf16_f32 v80, v48, v49
    v_pk_mul_f32 v[50:51], v[50:51], v[64:65] op_sel_hi:[1,0]
    v_cvt_pk_bf16_f32 v81, v50, v51
    v_pk_mul_f32 v[52:53], v[52:53], v[68:69] op_sel_hi:[1,0]
    v_cvt_pk_bf16_f32 v82, v52, v53
    v_pk_mul_f32 v[54:55], v[54:55], v[68:69] op_sel_hi:[1,0]
    v_cvt_pk_bf16_f32 v83, v54, v55
    v_permlane16_swap_b32 v80, v82
    s_nop 0
    v_permlane16_swap_b32 v81, v83
    buffer_store_dwordx4 v[80:83], v13, s[48:51], s59 offen sc1
    v_pk_mul_f32 v[56:57], v[56:57], v[72:73] op_sel_hi:[1,0]
    v_cvt_pk_bf16_f32 v84, v56, v57
    v_pk_mul_f32 v[58:59], v[58:59], v[72:73] op_sel_hi:[1,0]
    v_cvt_pk_bf16_f32 v85, v58, v59
    v_pk_mul_f32 v[60:61], v[60:61], v[76:77] op_sel_hi:[1,0]
    v_cvt_pk_bf16_f32 v86, v60, v61
    v_pk_mul_f32 v[62:63], v[62:63], v[76:77] op_sel_hi:[1,0]
    v_cvt_pk_bf16_f32 v87, v62, v63
    v_permlane16_swap_b32 v84, v86
    s_nop 0
    v_permlane16_swap_b32 v85, v87
    buffer_store_dwordx4 v[84:87], v14, s[48:51], s59 offen sc1
    s_add_u32 m0, s60, 90112
    s_xor_b32 s8, s72, 458752
    buffer_load_dwordx4 v156, s[32:35], s8 offen offset:0 lds
    buffer_load_dwordx4 v157, s[32:35], s8 offen offset:1024 lds
    s_waitcnt vmcnt(10)
    s_barrier
    s_xor_b32 s8, s15, 2
    s_add_u32 m0, s73, 0
    s_mul_i32 s8, s8, 88064
    buffer_load_dwordx4 v2, s[36:39], s8 offen offset:0 lds
    ds_read_b64_tr_b16 a[0:1], v6 offset:0
    ds_read_b64_tr_b16 a[2:3], v6 offset:768
    buffer_load_dwordx4 v3, s[36:39], s8 offen offset:1024 lds
    ds_read_b64_tr_b16 a[64:65], v6 offset:64
    ds_read_b64_tr_b16 a[66:67], v6 offset:832
    ds_read_b64_tr_b16 a[128:129], v6 offset:128
    ds_read_b64_tr_b16 a[130:131], v6 offset:896
    s_waitcnt vmcnt(12)
    s_barrier
    buffer_load_dwordx4 v4, s[36:39], s8 offen offset:2048 lds
    ds_read_b64_tr_b16 a[4:5], v6 offset:12288
    ds_read_b64_tr_b16 a[6:7], v6 offset:13056
    s_nop 0
    s_xor_b32 s8, s15, 3
    s_add_u32 m0, s73, 12288
    s_mul_i32 s8, s8, 88064
    buffer_load_dwordx4 v2, s[36:39], s8 offen offset:0 lds
    ds_read_b64_tr_b16 a[68:69], v6 offset:12352
    ds_read_b64_tr_b16 a[70:71], v6 offset:13120
    ds_read_b64_tr_b16 a[132:133], v6 offset:12416
    ds_read_b64_tr_b16 a[134:135], v6 offset:13184
    s_waitcnt vmcnt(6)
    s_mov_b32 s1, 1
    s_atomic_add s1, s[22:23], s61 offset:0 glc
    buffer_load_dwordx4 v3, s[36:39], s8 offen offset:1024 lds
    s_waitcnt vmcnt(5)
    s_barrier
    ds_read_b64_tr_b16 a[192:193], v8 offset:32768
    ds_read_b64_tr_b16 a[194:195], v8 offset:33280
    ds_read_b64_tr_b16 a[196:197], v8 offset:36864
    buffer_load_dwordx4 v4, s[36:39], s8 offen offset:2048 lds
    ds_read_b64_tr_b16 a[198:199], v8 offset:37376
    ds_read_b64_tr_b16 a[200:201], v8 offset:40960
    ds_read_b64_tr_b16 a[202:203], v8 offset:41472
    ds_read_b64_tr_b16 a[204:205], v8 offset:45056
    ds_read_b64_tr_b16 a[206:207], v8 offset:45568
    s_xor_b32 s8, s15, 4
    s_add_u32 m0, s73, 24576
    s_nop 0
    s_mul_i32 s8, s8, 88064
    buffer_load_dwordx4 v2, s[36:39], s8 offen offset:0 lds
    ds_read_b64_tr_b16 a[208:209], v8 offset:49152
    ds_read_b64_tr_b16 a[210:211], v8 offset:49664
    ds_read_b64_tr_b16 a[212:213], v8 offset:53248
    ds_read_b64_tr_b16 a[214:215], v8 offset:53760
    buffer_load_dwordx4 v3, s[36:39], s8 offen offset:1024 lds
    ds_read_b64_tr_b16 a[216:217], v8 offset:57344
    ds_read_b64_tr_b16 a[218:219], v8 offset:57856
    ds_read_b64_tr_b16 a[220:221], v8 offset:61440
    ds_read_b64_tr_b16 a[222:223], v8 offset:61952
    buffer_load_dwordx4 v4, s[36:39], s8 offen offset:2048 lds
    ds_read_b64_tr_b16 a[224:225], v8 offset:0
    ds_read_b64_tr_b16 a[226:227], v8 offset:512
    ds_read_b64_tr_b16 a[228:229], v8 offset:4096
    ds_read_b64_tr_b16 a[230:231], v8 offset:4608
    ds_read_b64_tr_b16 a[232:233], v8 offset:8192
    s_nop 0
    s_xor_b32 s8, s15, 5
    s_add_u32 m0, s73, 36864
    s_mul_i32 s8, s8, 88064
    buffer_load_dwordx4 v2, s[36:39], s8 offen offset:0 lds
    ds_read_b64_tr_b16 a[234:235], v8 offset:8704
    ds_read_b64_tr_b16 a[236:237], v8 offset:12288
    ds_read_b64_tr_b16 a[238:239], v8 offset:12800
    ds_read_b64_tr_b16 a[240:241], v8 offset:16384
    buffer_load_dwordx4 v3, s[36:39], s8 offen offset:1024 lds
    ds_read_b64_tr_b16 a[242:243], v8 offset:16896
    ds_read_b64_tr_b16 a[244:245], v8 offset:20480
    ds_read_b64_tr_b16 a[246:247], v8 offset:20992
    ds_read_b64_tr_b16 a[248:249], v8 offset:24576
    buffer_load_dwordx4 v4, s[36:39], s8 offen offset:2048 lds
    ds_read_b64_tr_b16 a[250:251], v8 offset:25088
    ds_read_b64_tr_b16 a[252:253], v8 offset:28672
    ds_read_b64_tr_b16 a[254:255], v8 offset:29184
    v_add_u32 v7, s16, v1
    v_lshrrev_b32 v8, 5, v10
    v_lshlrev_b32_e64 v8, 11, v8
    v_bfe_u32 v15, v10, 4, 1
    v_lshl_add_u32 v8, v15, 9, v8
    v_and_b32 v15, 15, v10
    v_lshl_add_u32 v15, v15, 4, v8
    v_add_u32 v8, 0x10000, v15
    s_lshl_b32 s66, s52, 13
    s_xor_b32 s19, s27, 512
    s_mul_i32 s69, s52, 98304
    s_lshl_b32 s56, s52, 16
    s_add_u32 s56, s56, 1146880
    s_add_u32 s57, s69, 393216
    s_add_u32 s58, s69, 786432
    s_and_b32 s71, s53, 1
    s_cselect_b32 s64, s57, s69
    s_cselect_b32 s65, s69, s57
    s_cselect_b32 s67, s56, s58
    s_cselect_b32 s68, s58, s56
    s_lshl_b32 s71, s71, 15
    s_and_b32 s58, s21, 15
    s_lshl_b32 s58, s58, 19
    s_lshr_b32 s57, s58, 8
    s_and_b32 s57, s57, 0x2000
    s_xor_b32 s57, s57, s13
    s_add_u32 s58, s58, s57
    s_lshr_b32 s56, s52, 1
    s_lshl1_add_u32 s56, s11, s56
    s_and_b32 s57, s56, 28
    s_add_u32 s56, s56, s57
    s_and_b32 s57, s52, 1
    s_lshl2_add_u32 s56, s56, s57
    s_lshl_b32 s56, s56, 9
    s_add_u32 s56, s56, s58
    s_add_u32 s5, s56, 8388608
    s_xor_b32 s6, s5, 0x80000
    s_lshl1_add_u32 s4, s14, s57
    s_lshl_b32 s4, s4, 11
    s_add_u32 s4, s4, 131072
    s_and_b32 s7, s53, 15
    s_lshl_b32 s7, s7, 19
    s_lshr_b32 s57, s7, 8
    s_and_b32 s57, s57, 0x2000
    s_xor_b32 s57, s57, s13
    s_add_u32 s7, s7, s57
    s_lshr_b32 s57, s20, 1
    s_and_b32 s57, s57, 0x4000
    s_and_b32 s58, s20, 0x1000
    s_add_u32 s57, s57, s58
    s_add_u32 s7, s7, s57
    s_add_u32 s7, s7, 8388608
    s_cmp_lt_u32 s52, 3
    s_cselect_b32 s57, s7, 1073741824
    v_add_u32 v12, s57, v15
    v_add_u32 v15, s7, v15
    s_sub_u32 s57, s66, 32768
    v_add_u32 v9, s57, v9
    v_xor_b32 v14, 0x60, v9
    v_and_b32 v13, 15, v10
    v_lshrrev_b32 v11, 5, v10
    v_lshl_add_u32 v13, v11, 4, v13
    v_lshlrev_b32 v13, 4, v13
    v_bfe_u32 v11, v10, 4, 1
    v_lshl_add_u32 v239, v11, 9, v13
    v_lshl_add_u32 v238, v11, 17, v13
    v_lshl_add_u32 v11, v11, 30, v13
    s_cmp_lt_u32 s11, 11
    s_cselect_b32 s57, 0x40000, 1073741824
    v_or_b32_e64 v11, s57, v11
    s_waitcnt lgkmcnt(0)
    s_barrier
    s_cmp_eq_u32 s1, 7
    s_cbranch_scc0 L_slow_19
L_ok_18:
    s_add_u32 m0, s60, 65536
    s_xor_b32 s8, s24, 0
    buffer_load_dwordx4 v7, s[48:51], s8 offen offset:0 sc1 lds
    buffer_load_dwordx4 v7, s[48:51], s8 offen offset:1024 sc1 lds
    s_add_u32 m0, s60, 73728
    s_xor_b32 s8, s24, 16384
    buffer_load_dwordx4 v7, s[48:51], s8 offen offset:0 sc1 lds
    buffer_load_dwordx4 v7, s[48:51], s8 offen offset:1024 sc1 lds
    s_waitcnt vmcnt(13)
    s_barrier
    v_mfma_f32_16x16x32_bf16 v[96:99], v[116:119], a[0:3], 0
    s_add_u32 m0, s60, 81920
    s_xor_b32 s8, s24, 32768
    buffer_load_dwordx4 v7, s[48:51], s8 offen offset:0 sc1 lds
    ds_read_b64_tr_b16 a[8:9], v5 offset:0
    ds_read_b64_tr_b16 a[10:11], v5 offset:768
    v_mfma_f32_16x16x32_bf16 v[100:103], v[116:119], a[64:67], 0
    buffer_load_dwordx4 v7, s[48:51], s8 offen offset:1024 sc1 lds
    ds_read_b64_tr_b16 a[72:73], v5 offset:64
    ds_read_b64_tr_b16 a[74:75], v5 offset:832
    v_mfma_f32_16x16x32_bf16 v[104:107], v[116:119], a[128:131], 0
    ds_read_b64_tr_b16 a[136:137], v5 offset:128
    ds_read_b64_tr_b16 a[138:139], v5 offset:896
    s_waitcnt vmcnt(12)
    s_barrier
    v_mfma_f32_16x16x32_bf16 v[96:99], v[116:119], a[4:7], v[96:99]
    s_add_u32 m0, s60, 90112
    s_xor_b32 s8, s24, 49152
    buffer_load_dwordx4 v7, s[48:51], s8 offen offset:0 sc1 lds
    ds_read_b64_tr_b16 a[12:13], v5 offset:12288
    ds_read_b64_tr_b16 a[14:15], v5 offset:13056
    v_mfma_f32_16x16x32_bf16 v[100:103], v[116:119], a[68:71], v[100:103]
    buffer_load_dwordx4 v7, s[48:51], s8 offen offset:1024 sc1 lds
    ds_read_b64_tr_b16 a[76:77], v5 offset:12352
    ds_read_b64_tr_b16 a[78:79], v5 offset:13120
    v_mfma_f32_16x16x32_bf16 v[104:107], v[116:119], a[132:135], v[104:107]
    ds_read_b64_tr_b16 a[140:141], v5 offset:12416
    ds_read_b64_tr_b16 a[142:143], v5 offset:13184
    s_waitcnt vmcnt(11) lgkmcnt(6)
    s_barrier
    v_mfma_f32_16x16x32_bf16 v[96:99], v[116:119], a[8:11], v[96:99]
    s_add_u32 m0, s60, 98304
    s_xor_b32 s8, s24, 65536
    buffer_load_dwordx4 v7, s[48:51], s8 offen offset:0 sc1 lds
    ds_read_b64_tr_b16 a[16:17], v5 offset:24576
    ds_read_b64_tr_b16 a[18:19], v5 offset:25344
    v_mfma_f32_16x16x32_bf16 v[100:103], v[116:119], a[72:75], v[100:103]
    buffer_load_dwordx4 v7, s[48:51], s8 offen offset:1024 sc1 lds
    ds_read_b64_tr_b16 a[80:81], v5 offset:24640
    ds_read_b64_tr_b16 a[82:83], v5 offset:25408
    v_mfma_f32_16x16x32_bf16 v[104:107], v[116:119], a[136:139], v[104:107]
    ds_read_b64_tr_b16 a[144:145], v5 offset:24704
    ds_read_b64_tr_b16 a[146:147], v5 offset:25472
    s_waitcnt vmcnt(10) lgkmcnt(6)
    s_barrier
    v_mfma_f32_16x16x32_bf16 v[96:99], v[116:119], a[12:15], v[96:99]
    s_add_u32 m0, s60, 106496
    s_xor_b32 s8, s24, 81920
    buffer_load_dwordx4 v7, s[48:51], s8 offen offset:0 sc1 lds
    ds_read_b64_tr_b16 a[20:21], v5 offset:36864
    ds_read_b64_tr_b16 a[22:23], v5 offset:37632
    v_mfma_f32_16x16x32_bf16 v[100:103], v[116:119], a[76:79], v[100:103]
    buffer_load_dwordx4 v7, s[48:51], s8 offen offset:1024 sc1 lds
    ds_read_b64_tr_b16 a[84:85], v5 offset:36928
    ds_read_b64_tr_b16 a[86:87], v5 offset:37696
    v_mfma_f32_16x16x32_bf16 v[104:107], v[116:119], a[140:143], v[104:107]
    ds_read_b64_tr_b16 a[148:149], v5 offset:36992
    ds_read_b64_tr_b16 a[150:151], v5 offset:37760
    s_add_u32 m0, s60, 114688
    s_xor_b32 s8, s24, 98304
    buffer_load_dwordx4 v7, s[48:51], s8 offen offset:0 sc1 lds
    buffer_load_dwordx4 v7, s[48:51], s8 offen offset:1024 sc1 lds
    s_add_u32 m0, s60, 122880
    s_xor_b32 s8, s24, 114688
    buffer_load_dwordx4 v7, s[48:51], s8 offen offset:0 sc1 lds
    buffer_load_dwordx4 v7, s[48:51], s8 offen offset:1024 sc1 lds
    s_waitcnt vmcnt(12) lgkmcnt(0)
    s_barrier
    ds_read_b128 v[32:35], v8 offset:0
    ds_read_b128 v[36:39], v8 offset:256
    ds_read_b128 v[40:43], v8 offset:1024
    ds_read_b128 v[44:47], v8 offset:1280
    ds_read_b128 v[48:51], v8 offset:4096
    ds_read_b128 v[52:55], v8 offset:4352
    ds_read_b128 v[56:59], v8 offset:5120
    ds_read_b128 v[60:63], v8 offset:5376
    ds_read_b128 v[64:67], v8 offset:8192
    ds_read_b128 v[68:71], v8 offset:8448
    ds_read_b128 v[72:75], v8 offset:9216
    ds_read_b128 v[76:79], v8 offset:9472
    s_waitcnt lgkmcnt(8)
    v_mfma_f32_16x16x32_bf16 v[16:19], a[192:195], v[32:35], v[16:19]
    ds_read_b128 v[80:83], v8 offset:12288
    s_xor_b32 s8, s15, 6
    s_add_u32 m0, s73, 49152
    s_mul_i32 s8, s8, 88064
    buffer_load_dwordx4 v2, s[36:39], s8 offen offset:0 lds
    v_mfma_f32_16x16x32_bf16 v[20:23], a[192:195], v[36:39], v[20:23]
    ds_read_b128 v[84:87], v8 offset:12544
    v_mfma_f32_16x16x32_bf16 v[24:27], a[192:195], v[40:43], v[24:27]
    s_nop 0
    ds_read_b128 v[88:91], v8 offset:13312
    v_mfma_f32_16x16x32_bf16 v[28:31], a[192:195], v[44:47], v[28:31]
    s_waitcnt lgkmcnt(7)
    ds_read_b128 v[92:95], v8 offset:13568
    v_mfma_f32_16x16x32_bf16 v[16:19], a[196:199], v[48:51], v[16:19]
    s_waitcnt vmcnt(9)
    s_barrier
    ds_read_b128 v[32:35], v8 offset:16384
    buffer_load_dwordx4 v3, s[36:39], s8 offen offset:1024 lds
    v_mfma_f32_16x16x32_bf16 v[20:23], a[196:199], v[52:55], v[20:23]
    ds_read_b128 v[36:39], v8 offset:16640
    v_mfma_f32_16x16x32_bf16 v[24:27], a[196:199], v[56:59], v[24:27]
    s_nop 0
    ds_read_b128 v[40:43], v8 offset:17408
    v_mfma_f32_16x16x32_bf16 v[28:31], a[196:199], v[60:63], v[28:31]
    s_waitcnt lgkmcnt(7)
    ds_read_b128 v[44:47], v8 offset:17664
    v_mfma_f32_16x16x32_bf16 v[16:19], a[200:203], v[64:67], v[16:19]
    ds_read_b128 v[48:51], v8 offset:20480
    buffer_load_dwordx4 v4, s[36:39], s8 offen offset:2048 lds
    v_mfma_f32_16x16x32_bf16 v[20:23], a[200:203], v[68:71], v[20:23]
    ds_read_b128 v[52:55], v8 offset:20736
    v_mfma_f32_16x16x32_bf16 v[24:27], a[200:203], v[72:75], v[24:27]
    ds_read_b128 v[56:59], v8 offset:21504
    v_mfma_f32_16x16x32_bf16 v[28:31], a[200:203], v[76:79], v[28:31]
    s_waitcnt lgkmcnt(7)
    ds_read_b128 v[60:63], v8 offset:21760
    v_mfma_f32_16x16x32_bf16 v[16:19], a[204:207], v[80:83], v[16:19]
    s_nop 0
    ds_read_b128 v[64:67], v8 offset:24576
    v_mfma_f32_16x16x32_bf16 v[20:23], a[204:207], v[84:87], v[20:23]
    ds_read_b128 v[68:71], v8 offset:24832
    v_mfma_f32_16x16x32_bf16 v[24:27], a[204:207], v[88:91], v[24:27]
    ds_read_b128 v[72:75], v8 offset:25600
    v_mfma_f32_16x16x32_bf16 v[28:31], a[204:207], v[92:95], v[28:31]
    s_waitcnt lgkmcnt(7)
    ds_read_b128 v[76:79], v8 offset:25856
    v_mfma_f32_16x16x32_bf16 v[16:19], a[208:211], v[32:35], v[16:19]
    ds_read_b128 v[80:83], v8 offset:28672
    s_xor_b32 s8, s15, 7
    s_add_u32 m0, s73, 131072
    s_mul_i32 s8, s8, 88064
    buffer_load_dwordx4 v2, s[36:39], s8 offen offset:0 lds
    v_mfma_f32_16x16x32_bf16 v[20:23], a[208:211], v[36:39], v[20:23]
    ds_read_b128 v[84:87], v8 offset:28928
    v_mfma_f32_16x16x32_bf16 v[24:27], a[208:211], v[40:43], v[24:27]
    s_nop 0
    ds_read_b128 v[88:91], v8 offset:29696
    v_mfma_f32_16x16x32_bf16 v[28:31], a[208:211], v[44:47], v[28:31]
    s_waitcnt lgkmcnt(7)
    ds_read_b128 v[92:95], v8 offset:29952
    v_mfma_f32_16x16x32_bf16 v[16:19], a[212:215], v[48:51], v[16:19]
    s_waitcnt vmcnt(8)
    s_barrier
    ds_read_b128 v[32:35], v8 offset:32768
    buffer_load_dwordx4 v3, s[36:39], s8 offen offset:1024 lds
    v_mfma_f32_16x16x32_bf16 v[20:23], a[212:215], v[52:55], v[20:23]
    ds_read_b128 v[36:39], v8 offset:33024
    v_mfma_f32_16x16x32_bf16 v[24:27], a[212:215], v[56:59], v[24:27]
    ds_read_b128 v[40:43], v8 offset:33792
    v_mfma_f32_16x16x32_bf16 v[28:31], a[212:215], v[60:63], v[28:31]
    s_waitcnt lgkmcnt(7)
    ds_read_b128 v[44:47], v8 offset:34048
    v_mfma_f32_16x16x32_bf16 v[16:19], a[216:219], v[64:67], v[16:19]
    s_nop 0
    ds_read_b128 v[48:51], v8 offset:36864
    buffer_load_dwordx4 v4, s[36:39], s8 offen offset:2048 lds
    v_mfma_f32_16x16x32_bf16 v[20:23], a[216:219], v[68:71], v[20:23]
    ds_read_b128 v[52:55], v8 offset:37120
    v_mfma_f32_16x16x32_bf16 v[24:27], a[216:219], v[72:75], v[24:27]
    s_nop 0
    ds_read_b128 v[56:59], v8 offset:37888
    v_mfma_f32_16x16x32_bf16 v[28:31], a[216:219], v[76:79], v[28:31]
    s_waitcnt lgkmcnt(7)
    ds_read_b128 v[60:63], v8 offset:38144
    v_mfma_f32_16x16x32_bf16 v[16:19], a[220:223], v[80:83], v[16:19]
    ds_read_b128 v[64:67], v8 offset:40960
    v_mfma_f32_16x16x32_bf16 v[20:23], a[220:223], v[84:87], v[20:23]
    ds_read_b128 v[68:71], v8 offset:41216
    v_mfma_f32_16x16x32_bf16 v[24:27], a[220:223], v[88:91], v[24:27]
    ds_read_b128 v[72:75], v8 offset:41984
    v_mfma_f32_16x16x32_bf16 v[28:31], a[220:223], v[92:95], v[28:31]
    s_waitcnt lgkmcnt(7)
    ds_read_b128 v[76:79], v8 offset:42240
    v_mfma_f32_16x16x32_bf16 v[16:19], a[224:227], v[32:35], v[16:19]
    ds_read_b128 v[80:83], v8 offset:45056
    s_xor_b32 s8, s15, 8
    s_add_u32 m0, s73, 143360
    s_mul_i32 s8, s8, 88064
    buffer_load_dwordx4 v2, s[36:39], s8 offen offset:0 lds
    v_mfma_f32_16x16x32_bf16 v[20:23], a[224:227], v[36:39], v[20:23]
    ds_read_b128 v[84:87], v8 offset:45312
    v_mfma_f32_16x16x32_bf16 v[24:27], a[224:227], v[40:43], v[24:27]
    s_nop 0
    ds_read_b128 v[88:91], v8 offset:46080
    v_mfma_f32_16x16x32_bf16 v[28:31], a[224:227], v[44:47], v[28:31]
    s_waitcnt lgkmcnt(7)
    ds_read_b128 v[92:95], v8 offset:46336
    v_mfma_f32_16x16x32_bf16 v[16:19], a[228:231], v[48:51], v[16:19]
    s_waitcnt vmcnt(7)
    s_barrier
    ds_read_b128 v[32:35], v8 offset:49152
    buffer_load_dwordx4 v3, s[36:39], s8 offen offset:1024 lds
    v_mfma_f32_16x16x32_bf16 v[20:23], a[228:231], v[52:55], v[20:23]
    ds_read_b128 v[36:39], v8 offset:49408
    v_mfma_f32_16x16x32_bf16 v[24:27], a[228:231], v[56:59], v[24:27]
    s_nop 0
    ds_read_b128 v[40:43], v8 offset:50176
    v_mfma_f32_16x16x32_bf16 v[28:31], a[228:231], v[60:63], v[28:31]
    s_waitcnt lgkmcnt(7)
    ds_read_b128 v[44:47], v8 offset:50432
    v_mfma_f32_16x16x32_bf16 v[16:19], a[232:235], v[64:67], v[16:19]
    ds_read_b128 v[48:51], v8 offset:53248
    buffer_load_dwordx4 v4, s[36:39], s8 offen offset:2048 lds
    v_mfma_f32_16x16x32_bf16 v[20:23], a[232:235], v[68:71], v[20:23]
    ds_read_b128 v[52:55], v8 offset:53504
    v_mfma_f32_16x16x32_bf16 v[24:27], a[232:235], v[72:75], v[24:27]
    ds_read_b128 v[56:59], v8 offset:54272
    v_mfma_f32_16x16x32_bf16 v[28:31], a[232:235], v[76:79], v[28:31]
    s_waitcnt lgkmcnt(7)
    ds_read_b128 v[60:63], v8 offset:54528
    v_mfma_f32_16x16x32_bf16 v[16:19], a[236:239], v[80:83], v[16:19]
    s_nop 0
    ds_read_b128 v[64:67], v8 offset:57344
    v_mfma_f32_16x16x32_bf16 v[20:23], a[236:239], v[84:87], v[20:23]
    ds_read_b128 v[68:71], v8 offset:57600
    v_mfma_f32_16x16x32_bf16 v[24:27], a[236:239], v[88:91], v[24:27]
    ds_read_b128 v[72:75], v8 offset:58368
    v_mfma_f32_16x16x32_bf16 v[28:31], a[236:239], v[92:95], v[28:31]
    s_waitcnt lgkmcnt(7)
    ds_read_b128 v[76:79], v8 offset:58624
    v_mfma_f32_16x16x32_bf16 v[16:19], a[240:243], v[32:35], v[16:19]
    s_nop 0
    ds_read_b128 v[80:83], v8 offset:61440
    s_xor_b32 s8, s15, 9
    s_add_u32 m0, s73, 0
    s_mul_i32 s8, s8, 88064
    buffer_load_dwordx4 v2, s[36:39], s8 offen offset:0 lds
    v_mfma_f32_16x16x32_bf16 v[20:23], a[240:243], v[36:39], v[20:23]
    ds_read_b128 v[84:87], v8 offset:61696
    v_mfma_f32_16x16x32_bf16 v[24:27], a[240:243], v[40:43], v[24:27]
    ds_read_b128 v[88:91], v8 offset:62464
    v_mfma_f32_16x16x32_bf16 v[28:31], a[240:243], v[44:47], v[28:31]
    s_waitcnt lgkmcnt(7)
    ds_read_b128 v[92:95], v8 offset:62720
    v_mfma_f32_16x16x32_bf16 v[16:19], a[244:247], v[48:51], v[16:19]
    s_nop 0
    buffer_load_dwordx4 v3, s[36:39], s8 offen offset:1024 lds
    v_mfma_f32_16x16x32_bf16 v[20:23], a[244:247], v[52:55], v[20:23]
    v_mfma_f32_16x16x32_bf16 v[24:27], a[244:247], v[56:59], v[24:27]
    s_nop 0
    v_mfma_f32_16x16x32_bf16 v[28:31], a[244:247], v[60:63], v[28:31]
    s_waitcnt lgkmcnt(4)
    v_mfma_f32_16x16x32_bf16 v[16:19], a[248:251], v[64:67], v[16:19]
    buffer_load_dwordx4 v4, s[36:39], s8 offen offset:2048 lds
    v_mfma_f32_16x16x32_bf16 v[20:23], a[248:251], v[68:71], v[20:23]
    v_mfma_f32_16x16x32_bf16 v[24:27], a[248:251], v[72:75], v[24:27]
    s_nop 0
    v_mfma_f32_16x16x32_bf16 v[28:31], a[248:251], v[76:79], v[28:31]
    s_waitcnt lgkmcnt(0)
    v_mfma_f32_16x16x32_bf16 v[16:19], a[252:255], v[80:83], v[16:19]
    v_mfma_f32_16x16x32_bf16 v[20:23], a[252:255], v[84:87], v[20:23]
    v_mfma_f32_16x16x32_bf16 v[24:27], a[252:255], v[88:91], v[24:27]
    v_mfma_f32_16x16x32_bf16 v[28:31], a[252:255], v[92:95], v[28:31]
    s_and_b32 s56, s53, 15
    s_lshl_b32 s56, s56, 17
    s_and_b32 s57, s63, 24
    s_add_u32 s57, s57, s63
    s_lshl_b32 s57, s57, 10
    s_add_u32 s56, s56, s57
    s_add_u32 s56, s56, s13
    s_add_u32 s56, s56, 4194304
    s_add_u32 s57, s56, 65536
    s_lshr_b32 s58, s60, 2
    v_lshl_add_u32 v13, v10, 3, s58
    v_cvt_pk_bf16_f32 v80, v16, v17
    v_cvt_pk_bf16_f32 v81, v18, v19
    v_cvt_pk_bf16_f32 v82, v20, v21
    v_cvt_pk_bf16_f32 v83, v22, v23
    s_nop 0
    v_permlane16_swap_b32 v80, v82
    v_permlane16_swap_b32 v81, v83
    s_nop 0
    buffer_store_dwordx4 v[80:83], v1, s[48:51], s56 offen sc1
    v_cvt_pk_bf16_f32 v84, v24, v25
    v_cvt_pk_bf16_f32 v85, v26, v27
    v_cvt_pk_bf16_f32 v86, v28, v29
    v_cvt_pk_bf16_f32 v87, v30, v31
    s_nop 0
    v_permlane16_swap_b32 v84, v86
    v_permlane16_swap_b32 v85, v87
L_pad3:
    s_cbranch_execz L_back
    buffer_store_dwordx4 v[84:87], v1, s[48:51], s57 offen sc1
    v_pk_add_f32 v[72:73], v[16:17], v[18:19]
    v_pk_mul_f32 v[74:75], v[16:17], v[16:17]
    v_pk_fma_f32 v[74:75], v[18:19], v[18:19], v[74:75]
    v_add_f32 v64, v72, v73
    v_add_f32 v68, v74, v75
    v_pk_add_f32 v[72:73], v[20:21], v[22:23]
    v_pk_mul_f32 v[74:75], v[20:21], v[20:21]
    v_pk_fma_f32 v[74:75], v[22:23], v[22:23], v[74:75]
    v_add_f32 v65, v72, v73
    v_add_f32 v69, v74, v75
    v_pk_add_f32 v[72:73], v[24:25], v[26:27]
    v_pk_mul_f32 v[74:75], v[24:25], v[24:25]
    v_pk_fma_f32 v[74:75], v[26:27], v[26:27], v[74:75]
    v_add_f32 v66, v72, v73
    v_add_f32 v70, v74, v75
    v_pk_add_f32 v[72:73], v[28:29], v[30:31]
    v_pk_mul_f32 v[74:75], v[28:29], v[28:29]
    v_pk_fma_f32 v[74:75], v[30:31], v[30:31], v[74:75]
    v_add_f32 v67, v72, v73
    v_add_f32 v71, v74, v75
    v_permlane16_swap_b32 v64, v65
    v_permlane16_swap_b32 v66, v67
    v_permlane16_swap_b32 v68, v69
    v_permlane16_swap_b32 v70, v71
    v_add_f32 v64, v64, v65
    v_add_f32 v66, v66, v67
    v_add_f32 v68, v68, v69
    v_add_f32_e64 v70, v70, v71
    v_permlane32_swap_b32 v64, v66
    s_nop 0
    v_permlane32_swap_b32 v68, v70
    v_add_f32_e64 v72, v64, v66
    v_add_f32 v73, v68, v70
    ds_write_b64 v13, v[72:73] offset:61440
    s_xor_b32 s8, s15, 10
    s_add_u32 m0, s73, 12288
    s_mul_i32 s8, s8, 88064
    buffer_load_dwordx4 v2, s[36:39], s8 offen offset:0 lds
    buffer_load_dwordx4 v3, s[36:39], s8 offen offset:1024 lds
    buffer_load_dwordx4 v4, s[36:39], s8 offen offset:2048 lds
    s_waitcnt vmcnt(14) lgkmcnt(0)
    s_barrier
    s_cmp_eq_u32 s52, 0
    s_cbranch_scc0 L_ns_21
    ds_read_b64 v[74:75], v13 offset:61952
    ds_read_b64 v[76:77], v13 offset:62464
    ds_read_b64 v[78:79], v13 offset:62976
    s_lshl3_add_u32 s56, s53, s54
    s_lshl_b32 s56, s56, 9
    s_add_u32 s56, s56, 131072
    v_and_b32_e64 v64, 31, v10
    v_lshrrev_b32_e64 v65, 5, v10
    v_lshlrev_b32_e64 v65, 3, v65
    v_lshl_add_u32 v64, v64, 4, v65
    s_waitcnt lgkmcnt(2)
    v_pk_add_f32 v[72:73], v[72:73], v[74:75]
    s_waitcnt lgkmcnt(0)
    v_pk_add_f32 v[76:77], v[76:77], v[78:79]
    v_pk_add_f32 v[72:73], v[72:73], v[76:77]
    v_min_u32 v72, -2, v72
    v_min_u32_e64 v73, -2, v73
    buffer_store_dwordx2 v[72:73], v64, s[48:51], s56 offen sc1
L_ns_21:
    v_mfma_f32_16x16x32_bf16 v[96:99], v[116:119], a[16:19], v[96:99]
    s_xor_b32 s8, s15, 11
    s_add_u32 m0, s73, 24576
    s_mul_i32 s8, s8, 88064
    buffer_load_dwordx4 v2, s[36:39], s8 offen offset:0 lds
    ds_read_b64_tr_b16 a[24:25], v5 offset:49152
    ds_read_b64_tr_b16 a[26:27], v5 offset:49920
    v_mfma_f32_16x16x32_bf16 v[100:103], v[116:119], a[80:83], v[100:103]
    buffer_load_dwordx4 v3, s[36:39], s8 offen offset:1024 lds
    ds_read_b64_tr_b16 a[88:89], v5 offset:49216
    ds_read_b64_tr_b16 a[90:91], v5 offset:49984
    v_mfma_f32_16x16x32_bf16 v[104:107], v[116:119], a[144:147], v[104:107]
    ds_read_b64_tr_b16 a[152:153], v5 offset:49280
    ds_read_b64_tr_b16 a[154:155], v5 offset:50048
    s_waitcnt vmcnt(13)
    s_barrier
    v_mfma_f32_16x16x32_bf16 v[96:99], v[116:119], a[20:23], v[96:99]
    buffer_load_dwordx4 v4, s[36:39], s8 offen offset:2048 lds
    ds_read_b64_tr_b16 a[28:29], v6 offset:0
    ds_read_b64_tr_b16 a[30:31], v6 offset:768
    v_mfma_f32_16x16x32_bf16 v[100:103], v[116:119], a[84:87], v[100:103]
    s_xor_b32 s8, s15, 12
    s_nop 0
    s_add_u32 m0, s73, 36864
    s_mul_i32 s8, s8, 88064
    buffer_load_dwordx4 v2, s[36:39], s8 offen offset:0 lds
    ds_read_b64_tr_b16 a[92:93], v6 offset:64
    ds_read_b64_tr_b16 a[94:95], v6 offset:832
    v_mfma_f32_16x16x32_bf16 v[104:107], v[116:119], a[148:151], v[104:107]
    ds_read_b64_tr_b16 a[156:157], v6 offset:128
    ds_read_b64_tr_b16 a[158:159], v6 offset:896
    s_waitcnt vmcnt(12) lgkmcnt(6)
    s_barrier
    v_mfma_f32_16x16x32_bf16 v[96:99], v[116:119], a[24:27], v[96:99]
    buffer_load_dwordx4 v3, s[36:39], s8 offen offset:1024 lds
    ds_read_b64_tr_b16 a[32:33], v6 offset:12288
    ds_read_b64_tr_b16 a[34:35], v6 offset:13056
    v_mfma_f32_16x16x32_bf16 v[100:103], v[116:119], a[88:91], v[100:103]
    buffer_load_dwordx4 v4, s[36:39], s8 offen offset:2048 lds
    ds_read_b64_tr_b16 a[96:97], v6 offset:12352
    ds_read_b64_tr_b16 a[98:99], v6 offset:13120
    v_mfma_f32_16x16x32_bf16 v[104:107], v[116:119], a[152:155], v[104:107]
    ds_read_b64_tr_b16 a[160:161], v6 offset:12416
    ds_read_b64_tr_b16 a[162:163], v6 offset:13184
    s_waitcnt vmcnt(9)
    s_atomic_add s62, s[22:23], s25 offset:16384
    s_waitcnt lgkmcnt(6)
    s_barrier
    v_mfma_f32_16x16x32_bf16 v[96:99], v[116:119], a[28:31], v[96:99]
    s_xor_b32 s8, s15, 13
    s_add_u32 m0, s73, 49152
    s_mul_i32 s8, s8, 88064
    buffer_load_dwordx4 v2, s[36:39], s8 offen offset:0 lds
    ds_read_b64_tr_b16 a[36:37], v5 offset:0
    ds_read_b64_tr_b16 a[38:39], v5 offset:768
    v_mfma_f32_16x16x32_bf16 v[100:103], v[116:119], a[92:95], v[100:103]
    buffer_load_dwordx4 v3, s[36:39], s8 offen offset:1024 lds
    ds_read_b64_tr_b16 a[100:101], v5 offset:64
    ds_read_b64_tr_b16 a[102:103], v5 offset:832
    v_mfma_f32_16x16x32_bf16 v[104:107], v[116:119], a[156:159], v[104:107]
    buffer_load_dwordx4 v4, s[36:39], s8 offen offset:2048 lds
    ds_read_b64_tr_b16 a[164:165], v5 offset:128
    ds_read_b64_tr_b16 a[166:167], v5 offset:896
    s_waitcnt vmcnt(9) lgkmcnt(6)
    s_barrier
    v_mfma_f32_16x16x32_bf16 v[96:99], v[116:119], a[32:35], v[96:99]
    s_xor_b32 s8, s15, 14
    s_nop 0
    s_add_u32 m0, s73, 131072
    s_mul_i32 s8, s8, 88064
    buffer_load_dwordx4 v2, s[36:39], s8 offen offset:0 lds
    ds_read_b64_tr_b16 a[40:41], v5 offset:12288
    ds_read_b64_tr_b16 a[42:43], v5 offset:13056
    v_mfma_f32_16x16x32_bf16 v[100:103], v[116:119], a[96:99], v[100:103]
    buffer_load_dwordx4 v3, s[36:39], s8 offen offset:1024 lds
    ds_read_b64_tr_b16 a[104:105], v5 offset:12352
    ds_read_b64_tr_b16 a[106:107], v5 offset:13120
    v_mfma_f32_16x16x32_bf16 v[104:107], v[116:119], a[160:163], v[104:107]
    buffer_load_dwordx4 v4, s[36:39], s8 offen offset:2048 lds
    ds_read_b64_tr_b16 a[168:169], v5 offset:12416
    ds_read_b64_tr_b16 a[170:171], v5 offset:13184
    s_mov_b32 s1, 0
    s_atomic_add s1, s[22:23], s26 offset:16384 glc
    s_waitcnt vmcnt(9) lgkmcnt(6)
    s_barrier
    v_mfma_f32_16x16x32_bf16 v[96:99], v[116:119], a[36:39], v[96:99]
    s_xor_b32 s8, s15, 15
    s_add_u32 m0, s73, 143360
    s_mul_i32 s8, s8, 88064
    buffer_load_dwordx4 v2, s[36:39], s8 offen offset:0 lds
    ds_read_b64_tr_b16 a[44:45], v5 offset:24576
    ds_read_b64_tr_b16 a[46:47], v5 offset:25344
    v_mfma_f32_16x16x32_bf16 v[100:103], v[116:119], a[100:103], v[100:103]
    buffer_load_dwordx4 v3, s[36:39], s8 offen offset:1024 lds
    ds_read_b64_tr_b16 a[108:109], v5 offset:24640
    ds_read_b64_tr_b16 a[110:111], v5 offset:25408
    v_mfma_f32_16x16x32_bf16 v[104:107], v[116:119], a[164:167], v[104:107]
    buffer_load_dwordx4 v4, s[36:39], s8 offen offset:2048 lds
    ds_read_b64_tr_b16 a[172:173], v5 offset:24704
    ds_read_b64_tr_b16 a[174:175], v5 offset:25472
    s_waitcnt vmcnt(9) lgkmcnt(6)
    s_barrier
    v_mfma_f32_16x16x32_bf16 v[96:99], v[116:119], a[40:43], v[96:99]
    ds_read_b64_tr_b16 a[48:49], v5 offset:36864
    ds_read_b64_tr_b16 a[50:51], v5 offset:37632
    v_mfma_f32_16x16x32_bf16 v[100:103], v[116:119], a[104:107], v[100:103]
    ds_read_b64_tr_b16 a[112:113], v5 offset:36928
    ds_read_b64_tr_b16 a[114:115], v5 offset:37696
    v_mfma_f32_16x16x32_bf16 v[104:107], v[116:119], a[168:171], v[104:107]
    ds_read_b64_tr_b16 a[176:177], v5 offset:36992
    ds_read_b64_tr_b16 a[178:179], v5 offset:37760
    s_and_b32 s56, s14, 15
    s_lshl_b32 s56, s56, 17
    s_add_u32 s56, s56, s13
    s_and_b32 s57, s20, 0x1000
    s_add_u32 s56, s56, s57
    s_add_u32 s56, s56, 4194304
    v_add_u32_e64 v7, s56, v1
    s_lshl_b32 s15, s15, 12
    v_and_b32_e64 v4, 48, v10
    v_lshl_add_u32 v4, v4, 4, v1
    v_add_u32 v3, 0x10000, v4
    s_cmp_eq_u32 s1, 16
    s_cbranch_scc0 L_slow_23
L_ok_22:
    s_add_u32 m0, s20, 65536
    s_xor_b32 s8, s15, 0
    buffer_load_dwordx4 v7, s[48:51], s8 offen offset:0 sc1 lds
    buffer_load_dwordx4 v7, s[48:51], s8 offen offset:1024 sc1 lds
    buffer_load_dwordx4 v7, s[48:51], s8 offen offset:2048 sc1 lds
    buffer_load_dwordx4 v7, s[48:51], s8 offen offset:3072 sc1 lds
    s_add_u32 m0, s20, 73728
    s_xor_b32 s8, s15, 16384
    buffer_load_dwordx4 v7, s[48:51], s8 offen offset:0 sc1 lds
    buffer_load_dwordx4 v7, s[48:51], s8 offen offset:1024 sc1 lds
    buffer_load_dwordx4 v7, s[48:51], s8 offen offset:2048 sc1 lds
    buffer_load_dwordx4 v7, s[48:51], s8 offen offset:3072 sc1 lds
    s_waitcnt vmcnt(14) lgkmcnt(6)
    s_barrier
    v_mfma_f32_16x16x32_bf16 v[96:99], v[116:119], a[44:47], v[96:99]
    buffer_load_dwordx4 v[240:243], v239, s[48:51], s4 offen offset:0 sc1
    ds_read_b64_tr_b16 a[52:53], v5 offset:49152
    ds_read_b64_tr_b16 a[54:55], v5 offset:49920
    v_mfma_f32_16x16x32_bf16 v[100:103], v[116:119], a[108:111], v[100:103]
    buffer_load_dwordx4 v[244:247], v239, s[48:51], s4 offen offset:1024 sc1
    ds_read_b64_tr_b16 a[116:117], v5 offset:49216
    ds_read_b64_tr_b16 a[118:119], v5 offset:49984
    v_mfma_f32_16x16x32_bf16 v[104:107], v[116:119], a[172:175], v[104:107]
    ds_read_b64_tr_b16 a[180:181], v5 offset:49280
    ds_read_b64_tr_b16 a[182:183], v5 offset:50048
    s_waitcnt vmcnt(13) lgkmcnt(6)
    s_barrier
    v_mfma_f32_16x16x32_bf16 v[96:99], v[116:119], a[48:51], v[96:99]
    s_add_u32 m0, s20, 81920
    s_xor_b32 s8, s15, 32768
    buffer_load_dwordx4 v7, s[48:51], s8 offen offset:0 sc1 lds
    ds_read_b64_tr_b16 a[56:57], v6 offset:0
    ds_read_b64_tr_b16 a[58:59], v6 offset:768
    v_mfma_f32_16x16x32_bf16 v[100:103], v[116:119], a[112:115], v[100:103]
    buffer_load_dwordx4 v7, s[48:51], s8 offen offset:1024 sc1 lds
    ds_read_b64_tr_b16 a[120:121], v6 offset:64
    ds_read_b64_tr_b16 a[122:123], v6 offset:832
    v_mfma_f32_16x16x32_bf16 v[104:107], v[116:119], a[176:179], v[104:107]
    ds_read_b64_tr_b16 a[184:185], v6 offset:128
    ds_read_b64_tr_b16 a[186:187], v6 offset:896
    s_waitcnt vmcnt(12) lgkmcnt(6)
    s_barrier
    v_mfma_f32_16x16x32_bf16 v[96:99], v[116:119], a[52:55], v[96:99]
    buffer_load_dwordx4 v7, s[48:51], s8 offen offset:2048 sc1 lds
    ds_read_b64_tr_b16 a[60:61], v6 offset:12288
    ds_read_b64_tr_b16 a[62:63], v6 offset:13056
    v_mfma_f32_16x16x32_bf16 v[100:103], v[116:119], a[116:119], v[100:103]
    buffer_load_dwordx4 v7, s[48:51], s8 offen offset:3072 sc1 lds
    ds_read_b64_tr_b16 a[124:125], v6 offset:12352
    ds_read_b64_tr_b16 a[126:127], v6 offset:13120
    v_mfma_f32_16x16x32_bf16 v[104:107], v[116:119], a[180:183], v[104:107]
    ds_read_b64_tr_b16 a[188:189], v6 offset:12416
    ds_read_b64_tr_b16 a[190:191], v6 offset:13184
    v_lshrrev_b32 v13, 3, v10
    v_and_b32 v6, 2, v13
    v_and_b32 v2, 7, v10
    v_xor_b32 v2, v2, v6
    v_lshlrev_b32 v2, 4, v2
    v_lshl_add_u32 v2, v13, 10, v2
    s_lshl_b32 s58, s54, 7
    v_add_u32_e64 v2, s58, v2
    v_xor_b32_e64 v6, 64, v2
    v_add_u32 v6, 7168, v6
    v_xor_b32_e64 v8, 32, v9
    v_xor_b32 v5, 64, v9
    s_waitcnt lgkmcnt(0)
    v_mfma_f32_16x16x32_bf16 v[96:99], v[116:119], a[56:59], v[96:99]
    v_mfma_f32_16x16x32_bf16 v[100:103], v[116:119], a[120:123], v[100:103]
    v_mfma_f32_16x16x32_bf16 v[104:107], v[116:119], a[184:187], v[104:107]
    v_mfma_f32_16x16x32_bf16 v[96:99], v[116:119], a[60:63], v[96:99]
    v_mfma_f32_16x16x32_bf16 v[100:103], v[116:119], a[124:127], v[100:103]
    v_mfma_f32_16x16x32_bf16 v[104:107], v[116:119], a[188:191], v[104:107]
    s_waitcnt vmcnt(10)
    s_barrier
    ds_read_b128 a[240:243], v3 offset:32768
    ds_read_b128 a[244:247], v3 offset:33024
    ds_read_b128 a[248:251], v3 offset:34816
    ds_read_b128 a[252:255], v3 offset:35072
    s_waitcnt lgkmcnt(2)
    v_mfma_f32_16x16x32_bf16 v[32:35], a[0:3], a[240:243], 0
    s_nop 0
    ds_read_b128 v[80:83], v3 offset:36864
    v_mfma_f32_16x16x32_bf16 v[40:43], a[64:67], a[240:243], 0
    s_add_u32 m0, s20, 90112
    s_xor_b32 s8, s15, 49152
    buffer_load_dwordx4 v7, s[48:51], s8 offen offset:0 sc1 lds
    v_mfma_f32_16x16x32_bf16 v[48:51], a[128:131], a[240:243], 0
    v_mov_b32_e64 v116, v238
    v_mfma_f32_16x16x32_bf16 v[36:39], a[0:3], a[244:247], 0
    ds_read_b128 v[84:87], v3 offset:37120
    v_mfma_f32_16x16x32_bf16 v[44:47], a[64:67], a[244:247], 0
    s_nop 0
    v_mfma_f32_16x16x32_bf16 v[52:55], a[128:131], a[244:247], 0
    s_waitcnt lgkmcnt(2)
    buffer_load_dwordx4 v7, s[48:51], s8 offen offset:1024 sc1 lds
    v_mfma_f32_16x16x32_bf16 v[32:35], a[4:7], a[248:251], v[32:35]
    ds_read_b128 v[88:91], v3 offset:38912
    v_mfma_f32_16x16x32_bf16 v[40:43], a[68:71], a[248:251], v[40:43]
    v_mfma_f32_16x16x32_bf16 v[48:51], a[132:135], a[248:251], v[48:51]
    v_mfma_f32_16x16x32_bf16 v[36:39], a[4:7], a[252:255], v[36:39]
    ds_read_b128 v[92:95], v3 offset:39168
    v_mfma_f32_16x16x32_bf16 v[44:47], a[68:71], a[252:255], v[44:47]
    buffer_load_dwordx4 v7, s[48:51], s8 offen offset:2048 sc1 lds
    v_mfma_f32_16x16x32_bf16 v[52:55], a[132:135], a[252:255], v[52:55]
    s_waitcnt lgkmcnt(2)
    v_mfma_f32_16x16x32_bf16 v[32:35], a[8:11], v[80:83], v[32:35]
    s_waitcnt vmcnt(9)
    s_barrier
    ds_read_b128 a[240:243], v3 offset:40960
    v_mfma_f32_16x16x32_bf16 v[40:43], a[72:75], v[80:83], v[40:43]
    s_nop 0
    buffer_load_dwordx4 v7, s[48:51], s8 offen offset:3072 sc1 lds
    v_mfma_f32_16x16x32_bf16 v[48:51], a[136:139], v[80:83], v[48:51]
    v_mfma_f32_16x16x32_bf16 v[36:39], a[8:11], v[84:87], v[36:39]
    ds_read_b128 a[244:247], v3 offset:41216
    v_mfma_f32_16x16x32_bf16 v[44:47], a[72:75], v[84:87], v[44:47]
    s_nop 0
    v_mfma_f32_16x16x32_bf16 v[52:55], a[136:139], v[84:87], v[52:55]
    s_waitcnt lgkmcnt(2)
    buffer_load_dword v0, v0, s[40:43], 0 offen
    v_mfma_f32_16x16x32_bf16 v[32:35], a[12:15], v[88:91], v[32:35]
    ds_read_b128 a[248:251], v3 offset:43008
    v_mfma_f32_16x16x32_bf16 v[40:43], a[76:79], v[88:91], v[40:43]
    v_mfma_f32_16x16x32_bf16 v[48:51], a[140:143], v[88:91], v[48:51]
    v_mfma_f32_16x16x32_bf16 v[36:39], a[12:15], v[92:95], v[36:39]
    ds_read_b128 a[252:255], v3 offset:43264
    v_mfma_f32_16x16x32_bf16 v[44:47], a[76:79], v[92:95], v[44:47]
    s_nop 0
    v_mfma_f32_16x16x32_bf16 v[52:55], a[140:143], v[92:95], v[52:55]
    s_waitcnt lgkmcnt(2)
    v_mfma_f32_16x16x32_bf16 v[32:35], a[16:19], a[240:243], v[32:35]
    ds_read_b128 v[80:83], v3 offset:45056
    v_mfma_f32_16x16x32_bf16 v[40:43], a[80:83], a[240:243], v[40:43]
    v_mfma_f32_16x16x32_bf16 v[48:51], a[144:147], a[240:243], v[48:51]
    v_mfma_f32_16x16x32_bf16 v[36:39], a[16:19], a[244:247], v[36:39]
    ds_read_b128 v[84:87], v3 offset:45312
    v_mfma_f32_16x16x32_bf16 v[44:47], a[80:83], a[244:247], v[44:47]
    v_mfma_f32_16x16x32_bf16 v[52:55], a[144:147], a[244:247], v[52:55]
    s_waitcnt lgkmcnt(2)
    v_mfma_f32_16x16x32_bf16 v[32:35], a[20:23], a[248:251], v[32:35]
    s_nop 0
    ds_read_b128 v[88:91], v3 offset:47104
    s_waitcnt vmcnt(10)
    v_max_u32_e64 v13, v240, v241
    v_max3_u32 v13, v13, v242, v243
    s_waitcnt vmcnt(9)
    v_max3_u32 v13, v13, v244, v245
    v_mfma_f32_16x16x32_bf16 v[40:43], a[84:87], a[248:251], v[40:43]
    s_nop 0
    v_max3_u32 v13, v13, v246, v247
    v_cmp_eq_u32 vcc, -1, v13
    s_nop 0
    s_cbranch_vccnz L_again_26
L_ok_25:
    v_mfma_f32_16x16x32_bf16 v[48:51], a[148:151], a[248:251], v[48:51]
    v_mfma_f32_16x16x32_bf16 v[36:39], a[20:23], a[252:255], v[36:39]
    ds_read_b128 v[92:95], v3 offset:47360
    v_add_f32 v248, v240, v244
    v_mfma_f32_16x16x32_bf16 v[44:47], a[84:87], a[252:255], v[44:47]
    v_add_f32 v240, v240, v244
    v_add_f32_e64 v249, v241, v245
    v_mfma_f32_16x16x32_bf16 v[52:55], a[148:151], a[252:255], v[52:55]
    s_waitcnt lgkmcnt(2)
    v_permlane16_swap_b32 v240, v248
    v_mfma_f32_16x16x32_bf16 v[32:35], a[24:27], v[80:83], v[32:35]
    s_waitcnt vmcnt(5)
    s_barrier
    ds_read_b128 a[240:243], v3 offset:49152
    v_mfma_f32_16x16x32_bf16 v[40:43], a[88:91], v[80:83], v[40:43]
    v_add_f32_e64 v241, v241, v245
    v_add_f32 v250, v242, v246
    v_mfma_f32_16x16x32_bf16 v[48:51], a[152:155], v[80:83], v[48:51]
    v_permlane16_swap_b32 v241, v249
    v_mfma_f32_16x16x32_bf16 v[36:39], a[24:27], v[84:87], v[36:39]
    ds_read_b128 a[244:247], v3 offset:49408
    v_add_f32 v242, v242, v246
    v_mfma_f32_16x16x32_bf16 v[44:47], a[88:91], v[84:87], v[44:47]
    s_nop 0
    v_permlane16_swap_b32 v242, v250
    v_mfma_f32_16x16x32_bf16 v[52:55], a[152:155], v[84:87], v[52:55]
    s_waitcnt lgkmcnt(2)
    v_add_f32_e64 v251, v243, v247
    v_add_f32_e64 v243, v243, v247
    v_mfma_f32_16x16x32_bf16 v[32:35], a[28:31], v[88:91], v[32:35]
    ds_read_b128 a[248:251], v3 offset:51200
    v_add_u32 v13, s60, v1
    v_mfma_f32_16x16x32_bf16 v[40:43], a[92:95], v[88:91], v[40:43]
    v_permlane16_swap_b32 v243, v251
    v_mfma_f32_16x16x32_bf16 v[48:51], a[156:159], v[88:91], v[48:51]
    v_add_f32 v240, v240, v248
    v_add_f32 v241, v241, v249
    v_mfma_f32_16x16x32_bf16 v[36:39], a[28:31], v[92:95], v[36:39]
    ds_read_b128 a[252:255], v3 offset:51456
    v_add_f32_e64 v242, v242, v250
    v_mfma_f32_16x16x32_bf16 v[44:47], a[92:95], v[92:95], v[44:47]
    v_add_f32 v243, v243, v251
    v_mfma_f32_16x16x32_bf16 v[52:55], a[156:159], v[92:95], v[52:55]
    s_waitcnt lgkmcnt(2)
    ds_write_b128 v13, v[240:243] offset:57344
    v_mfma_f32_16x16x32_bf16 v[32:35], a[32:35], a[240:243], v[32:35]
    ds_read_b128 v[80:83], v3 offset:53248
    v_mfma_f32_16x16x32_bf16 v[40:43], a[96:99], a[240:243], v[40:43]
    v_mfma_f32_16x16x32_bf16 v[48:51], a[160:163], a[240:243], v[48:51]
    v_mfma_f32_16x16x32_bf16 v[36:39], a[32:35], a[244:247], v[36:39]
    ds_read_b128 v[84:87], v3 offset:53504
    v_mfma_f32_16x16x32_bf16 v[44:47], a[96:99], a[244:247], v[44:47]
    s_add_u32 m0, s20, 0
    s_xor_b32 s8, s15, 65536
    buffer_load_dwordx4 v7, s[48:51], s8 offen offset:0 sc1 lds
    v_mfma_f32_16x16x32_bf16 v[52:55], a[160:163], a[244:247], v[52:55]
    s_waitcnt lgkmcnt(3)
    v_mfma_f32_16x16x32_bf16 v[32:35], a[36:39], a[248:251], v[32:35]
    ds_read_b128 v[88:91], v3 offset:55296
    v_mfma_f32_16x16x32_bf16 v[40:43], a[100:103], a[248:251], v[40:43]
    buffer_load_dwordx4 v7, s[48:51], s8 offen offset:1024 sc1 lds
    v_mfma_f32_16x16x32_bf16 v[48:51], a[164:167], a[248:251], v[48:51]
    v_mfma_f32_16x16x32_bf16 v[36:39], a[36:39], a[252:255], v[36:39]
    ds_read_b128 v[92:95], v3 offset:55552
    v_mfma_f32_16x16x32_bf16 v[44:47], a[100:103], a[252:255], v[44:47]
    s_nop 0
    v_mfma_f32_16x16x32_bf16 v[52:55], a[164:167], a[252:255], v[52:55]
    s_waitcnt lgkmcnt(2)
    v_mfma_f32_16x16x32_bf16 v[32:35], a[40:43], v[80:83], v[32:35]
    s_waitcnt vmcnt(3)
    s_barrier
    ds_read_b128 a[240:243], v3 offset:57344
    v_mfma_f32_16x16x32_bf16 v[40:43], a[104:107], v[80:83], v[40:43]
    buffer_load_dwordx4 v7, s[48:51], s8 offen offset:2048 sc1 lds
    v_mfma_f32_16x16x32_bf16 v[48:51], a[168:171], v[80:83], v[48:51]
    ds_read_b128 v[248:251], v1 offset:61440
    v_mfma_f32_16x16x32_bf16 v[36:39], a[40:43], v[84:87], v[36:39]
    ds_read_b128 a[244:247], v3 offset:57600
    ds_read_b128 v[252:255], v1 offset:63488
    v_mfma_f32_16x16x32_bf16 v[44:47], a[104:107], v[84:87], v[44:47]
    s_nop 0
    buffer_load_dwordx4 v7, s[48:51], s8 offen offset:3072 sc1 lds
    v_mfma_f32_16x16x32_bf16 v[52:55], a[168:171], v[84:87], v[52:55]
    s_waitcnt lgkmcnt(4)
    ds_read_b128 v[240:243], v1 offset:57344
    v_mfma_f32_16x16x32_bf16 v[32:35], a[44:47], v[88:91], v[32:35]
    ds_read_b128 a[248:251], v3 offset:59392
    ds_read_b128 v[244:247], v1 offset:59392
    v_cvt_pk_bf16_f32 v13, v96, v96
    v_lshlrev_b32_e64 v13, 16, v13
    v_mfma_f32_16x16x32_bf16 v[40:43], a[108:111], v[88:91], v[40:43]
    v_sub_f32_e64 v13, v96, v13
    v_cvt_pk_bf16_f32 v96, v96, v13
    v_mfma_f32_16x16x32_bf16 v[48:51], a[172:175], v[88:91], v[48:51]
    v_cvt_pk_bf16_f32 v13, v100, v100
    v_lshlrev_b32_e64 v13, 16, v13
    v_mfma_f32_16x16x32_bf16 v[36:39], a[44:47], v[92:95], v[36:39]
    ds_read_b128 a[252:255], v3 offset:59648
    v_sub_f32_e64 v13, v100, v13
    v_mfma_f32_16x16x32_bf16 v[44:47], a[108:111], v[92:95], v[44:47]
    s_add_u32 m0, s20, 8192
    s_xor_b32 s8, s15, 81920
    buffer_load_dwordx4 v7, s[48:51], s8 offen offset:0 sc1 lds
    v_mfma_f32_16x16x32_bf16 v[52:55], a[172:175], v[92:95], v[52:55]
    s_waitcnt lgkmcnt(5)
    v_cvt_pk_bf16_f32 v100, v100, v13
    v_mfma_f32_16x16x32_bf16 v[32:35], a[48:51], a[240:243], v[32:35]
    s_nop 0
    ds_read_b128 v[80:83], v3 offset:61440
    v_cvt_pk_bf16_f32 v13, v104, v104
    v_mfma_f32_16x16x32_bf16 v[40:43], a[112:115], a[240:243], v[40:43]
    buffer_load_dwordx4 v7, s[48:51], s8 offen offset:1024 sc1 lds
    v_mfma_f32_16x16x32_bf16 v[48:51], a[176:179], a[240:243], v[48:51]
    v_lshlrev_b32 v13, 16, v13
    v_sub_f32 v13, v104, v13
    v_mfma_f32_16x16x32_bf16 v[36:39], a[48:51], a[244:247], v[36:39]
    ds_read_b128 v[84:87], v3 offset:61696
    v_cvt_pk_bf16_f32 v104, v104, v13
    v_mfma_f32_16x16x32_bf16 v[44:47], a[112:115], a[244:247], v[44:47]
    s_waitcnt lgkmcnt(6)
    v_add_f32 v120, v248, v252
    v_add_f32 v124, v249, v253
    v_mfma_f32_16x16x32_bf16 v[52:55], a[176:179], a[244:247], v[52:55]
    s_waitcnt lgkmcnt(2)
    v_add_f32 v121, v240, v244
    v_add_f32 v125, v241, v245
    v_mfma_f32_16x16x32_bf16 v[32:35], a[52:55], a[248:251], v[32:35]
    ds_read_b128 v[88:91], v3 offset:63488
    v_add_f32_e64 v122, v250, v254
    v_mfma_f32_16x16x32_bf16 v[40:43], a[116:119], a[248:251], v[40:43]
    buffer_load_dwordx4 v7, s[48:51], s8 offen offset:2048 sc1 lds
    v_mfma_f32_16x16x32_bf16 v[48:51], a[180:183], a[248:251], v[48:51]
    v_add_f32 v126, v251, v255
    v_add_f32 v123, v242, v246
    v_mfma_f32_16x16x32_bf16 v[36:39], a[52:55], a[252:255], v[36:39]
    ds_read_b128 v[92:95], v3 offset:63744
    v_add_f32_e64 v127, v243, v247
    v_mfma_f32_16x16x32_bf16 v[44:47], a[116:119], a[252:255], v[44:47]
    s_nop 0
    v_mul_f32 v120, 0xbb000000, v120
    v_mul_f32 v124, 0x3b000000, v124
    v_mfma_f32_16x16x32_bf16 v[52:55], a[180:183], a[252:255], v[52:55]
    s_waitcnt lgkmcnt(2)
    buffer_load_dwordx4 v7, s[48:51], s8 offen offset:3072 sc1 lds
    v_mfma_f32_16x16x32_bf16 v[32:35], a[56:59], v[80:83], v[32:35]
    ds_read_b128 a[240:243], v3 offset:0
    v_cvt_pk_bf16_f32 v98, v120, v120
    v_mfma_f32_16x16x32_bf16 v[40:43], a[120:123], v[80:83], v[40:43]
    v_cvt_pk_bf16_f32 v102, v120, v120
    v_fma_f32 v124, -v120, v120, v124
    v_mfma_f32_16x16x32_bf16 v[48:51], a[184:187], v[80:83], v[48:51]
    s_nop 0
    v_permlane32_swap_b32 v98, v102
    v_mfma_f32_16x16x32_bf16 v[36:39], a[56:59], v[84:87], v[36:39]
    ds_read_b128 a[244:247], v3 offset:256
    v_max_f32_e64 v124, 0, v124
    v_mfma_f32_16x16x32_bf16 v[44:47], a[120:123], v[84:87], v[44:47]
    s_add_u32 m0, s20, 16384
    s_xor_b32 s8, s15, 98304
    buffer_load_dwordx4 v7, s[48:51], s8 offen offset:0 sc1 lds
    v_mfma_f32_16x16x32_bf16 v[52:55], a[184:187], v[84:87], v[52:55]
    s_waitcnt lgkmcnt(2)
    v_add_f32 v124, 0x3727c5ac, v124
    v_mfma_f32_16x16x32_bf16 v[32:35], a[60:63], v[88:91], v[32:35]
    s_nop 0
    ds_read_b128 a[248:251], v3 offset:2048
    v_mfma_f32_16x16x32_bf16 v[40:43], a[124:127], v[88:91], v[40:43]
    v_rsq_f32_e64 v120, v124
    v_mfma_f32_16x16x32_bf16 v[48:51], a[188:191], v[88:91], v[48:51]
    buffer_load_dwordx4 v7, s[48:51], s8 offen offset:1024 sc1 lds
    v_mul_f32 v120, 0xbfb8aa3b, v120
    v_mfma_f32_16x16x32_bf16 v[36:39], a[60:63], v[92:95], v[36:39]
    ds_read_b128 a[252:255], v3 offset:2304
    v_mfma_f32_16x16x32_bf16 v[44:47], a[124:127], v[92:95], v[44:47]
    v_mfma_f32_16x16x32_bf16 v[52:55], a[188:191], v[92:95], v[52:55]
    s_waitcnt lgkmcnt(2)
    v_mfma_f32_16x16x16_bf16 v[32:35], v[96:97], v[98:99], v[32:35]
    s_barrier
    buffer_load_dwordx4 v7, s[48:51], s8 offen offset:2048 sc1 lds
    v_mfma_f32_16x16x16_bf16 v[36:39], v[96:97], v[102:103], v[36:39]
    v_mfma_f32_16x16x16_bf16 v[40:43], v[100:101], v[98:99], v[40:43]
    v_mfma_f32_16x16x16_bf16 v[44:47], v[100:101], v[102:103], v[44:47]
    v_mfma_f32_16x16x16_bf16 v[48:51], v[104:105], v[98:99], v[48:51]
    v_mfma_f32_16x16x16_bf16 v[52:55], v[104:105], v[102:103], v[52:55]
    buffer_load_dwordx4 v7, s[48:51], s8 offen offset:3072 sc1 lds
    v_mfma_f32_16x16x32_bf16 v[56:59], a[0:3], a[240:243], 0
    ds_read_b128 v[80:83], v3 offset:4096
    v_mfma_f32_16x16x32_bf16 v[64:67], a[64:67], a[240:243], 0
    v_mfma_f32_16x16x32_bf16 v[72:75], a[128:131], a[240:243], 0
    v_mfma_f32_16x16x32_bf16 v[60:63], a[0:3], a[244:247], 0
    s_nop 0
    ds_read_b128 v[84:87], v3 offset:4352
    v_permlane32_swap_b32 v32, v36
    v_permlane32_swap_b32 v33, v37
    v_mfma_f32_16x16x32_bf16 v[68:71], a[64:67], a[244:247], 0
    s_add_u32 m0, s66, 131072
    s_add_u32 s8, s64, 0
    buffer_load_dwordx4 v2, s[40:43], s8 offen offset:0 lds
    v_mfma_f32_16x16x32_bf16 v[76:79], a[128:131], a[244:247], 0
    s_waitcnt lgkmcnt(2)
    v_permlane32_swap_b32 v34, v38
    v_mfma_f32_16x16x32_bf16 v[56:59], a[4:7], a[248:251], v[56:59]
    ds_read_b128 v[88:91], v3 offset:6144
    v_permlane32_swap_b32 v35, v39
    v_mfma_f32_16x16x32_bf16 v[64:67], a[68:71], a[248:251], v[64:67]
    v_mul_f32 v36, v32, v36
    v_mul_f32_e64 v32, v32, v120
    v_mfma_f32_16x16x32_bf16 v[72:75], a[132:135], a[248:251], v[72:75]
    buffer_load_dwordx4 v6, s[40:43], s8 offen offset:1024 lds
    v_mul_f32_e64 v37, v33, v37
    v_mfma_f32_16x16x32_bf16 v[60:63], a[4:7], a[252:255], v[60:63]
    ds_read_b128 v[92:95], v3 offset:6400
    v_exp_f32 v32, v32
    v_mfma_f32_16x16x32_bf16 v[68:71], a[68:71], a[252:255], v[68:71]
    v_mul_f32 v33, v33, v120
    v_exp_f32 v33, v33
    v_mfma_f32_16x16x32_bf16 v[76:79], a[132:135], a[252:255], v[76:79]
    s_waitcnt lgkmcnt(2)
    v_fma_f32 v32, v32, v124, v124
    v_fma_f32 v33, v33, v124, v124
    v_mfma_f32_16x16x32_bf16 v[56:59], a[8:11], v[80:83], v[56:59]
    ds_read_b128 a[240:243], v3 offset:8192
    v_rcp_f32_e64 v32, v32
    v_mfma_f32_16x16x32_bf16 v[64:67], a[72:75], v[80:83], v[64:67]
    s_add_u32 s8, s64, 14336
    buffer_load_dwordx4 v2, s[40:43], s8 offen offset:2048 lds
    v_mul_f32 v32, v32, v36
    v_mfma_f32_16x16x32_bf16 v[72:75], a[136:139], v[80:83], v[72:75]
    v_rcp_f32 v33, v33
    v_mfma_f32_16x16x32_bf16 v[60:63], a[8:11], v[84:87], v[60:63]
    ds_read_b128 a[244:247], v3 offset:8448
    v_permlane32_swap_b32 v40, v44
    v_mfma_f32_16x16x32_bf16 v[68:71], a[72:75], v[84:87], v[68:71]
    v_permlane32_swap_b32 v41, v45
    v_mul_f32 v33, v33, v37
    v_mfma_f32_16x16x32_bf16 v[76:79], a[136:139], v[84:87], v[76:79]
    s_waitcnt lgkmcnt(2)
    buffer_load_dwordx4 v6, s[40:43], s8 offen offset:3072 lds
    v_mfma_f32_16x16x32_bf16 v[56:59], a[12:15], v[88:91], v[56:59]
    s_nop 0
    ds_read_b128 a[248:251], v3 offset:10240
    v_permlane32_swap_b32 v42, v46
    v_mfma_f32_16x16x32_bf16 v[64:67], a[76:79], v[88:91], v[64:67]
    s_nop 0
    v_permlane32_swap_b32 v43, v47
    v_cvt_pk_bf16_f32 v108, v32, v33
    v_mfma_f32_16x16x32_bf16 v[72:75], a[140:143], v[88:91], v[72:75]
    v_mul_f32 v38, v34, v38
    v_mul_f32 v34, v34, v120
    v_mul_f32_e64 v39, v35, v39
    v_mfma_f32_16x16x32_bf16 v[60:63], a[12:15], v[92:95], v[60:63]
    ds_read_b128 a[252:255], v3 offset:10496
    v_mul_f32_e64 v35, v35, v120
    v_mfma_f32_16x16x32_bf16 v[68:71], a[76:79], v[92:95], v[68:71]
L_pad4:
    s_cbranch_execz L_pad5
    s_add_u32 m0, s66, 135168
    s_add_u32 s8, s65, 0
    buffer_load_dwordx4 v2, s[40:43], s8 offen offset:0 lds
    v_mfma_f32_16x16x32_bf16 v[76:79], a[140:143], v[92:95], v[76:79]
    s_waitcnt lgkmcnt(2)
    v_exp_f32 v34, v34
    v_mul_f32_e64 v44, v40, v44
    v_mfma_f32_16x16x32_bf16 v[56:59], a[16:19], a[240:243], v[56:59]
    ds_read_b128 v[80:83], v3 offset:12288
    v_fma_f32 v34, v34, v124, v124
    v_mfma_f32_16x16x32_bf16 v[64:67], a[80:83], a[240:243], v[64:67]
    v_exp_f32 v35, v35
    v_mul_f32 v40, v40, v120
    v_mfma_f32_16x16x32_bf16 v[72:75], a[144:147], a[240:243], v[72:75]
    v_rcp_f32_e64 v34, v34
    v_fma_f32 v35, v35, v124, v124
    v_mfma_f32_16x16x32_bf16 v[60:63], a[16:19], a[244:247], v[60:63]
    ds_read_b128 v[84:87], v3 offset:12544
    v_mul_f32_e64 v34, v34, v38
    v_mfma_f32_16x16x32_bf16 v[68:71], a[80:83], a[244:247], v[68:71]
    buffer_load_dwordx4 v6, s[40:43], s8 offen offset:1024 lds
    v_mul_f32_e64 v45, v41, v45
    v_mfma_f32_16x16x32_bf16 v[76:79], a[144:147], a[244:247], v[76:79]
    s_waitcnt lgkmcnt(2)
    v_rcp_f32 v35, v35
    v_mul_f32_e64 v41, v41, v120
    v_mfma_f32_16x16x32_bf16 v[56:59], a[20:23], a[248:251], v[56:59]
    ds_read_b128 v[88:91], v3 offset:14336
    v_exp_f32_e64 v40, v40
    v_mfma_f32_16x16x32_bf16 v[64:67], a[84:87], a[248:251], v[64:67]
    s_add_u32 s8, s65, 14336
    buffer_load_dwordx4 v2, s[40:43], s8 offen offset:2048 lds
    v_mfma_f32_16x16x32_bf16 v[72:75], a[148:151], a[248:251], v[72:75]
    v_exp_f32 v41, v41
    v_mul_f32 v35, v35, v39
    v_mfma_f32_16x16x32_bf16 v[60:63], a[20:23], a[252:255], v[60:63]
    ds_read_b128 v[92:95], v3 offset:14592
    v_cvt_pk_bf16_f32 v109, v34, v35
    v_fma_f32 v40, v40, v124, v124
    v_mfma_f32_16x16x32_bf16 v[68:71], a[84:87], a[252:255], v[68:71]
    v_rcp_f32 v40, v40
    v_mfma_f32_16x16x32_bf16 v[76:79], a[148:151], a[252:255], v[76:79]
    s_waitcnt lgkmcnt(2)
    v_fma_f32 v41, v41, v124, v124
    v_rcp_f32_e64 v41, v41
    v_mfma_f32_16x16x32_bf16 v[56:59], a[24:27], v[80:83], v[56:59]
    ds_read_b128 a[240:243], v3 offset:16384
    v_mul_f32_e64 v40, v40, v44
    v_mul_f32_e64 v41, v41, v45
    v_mfma_f32_16x16x32_bf16 v[64:67], a[88:91], v[80:83], v[64:67]
    buffer_load_dwordx4 v6, s[40:43], s8 offen offset:3072 lds
    v_mfma_f32_16x16x32_bf16 v[72:75], a[152:155], v[80:83], v[72:75]
    v_cvt_pk_bf16_f32 v110, v40, v41
    s_nop 1
    v_permlane16_swap_b32 v108, v110
    v_mfma_f32_16x16x32_bf16 v[60:63], a[24:27], v[84:87], v[60:63]
    s_nop 0
    ds_read_b128 a[244:247], v3 offset:16640
    v_permlane32_swap_b32 v48, v52
    v_mfma_f32_16x16x32_bf16 v[68:71], a[88:91], v[84:87], v[68:71]
    s_add_u32 m0, s20, 24576
    s_xor_b32 s8, s15, 114688
    buffer_load_dwordx4 v7, s[48:51], s8 offen offset:0 sc1 lds
    v_mfma_f32_16x16x32_bf16 v[76:79], a[152:155], v[84:87], v[76:79]
    s_waitcnt lgkmcnt(2)
    v_permlane32_swap_b32 v49, v53
    v_mfma_f32_16x16x32_bf16 v[56:59], a[28:31], v[88:91], v[56:59]
    ds_read_b128 a[248:251], v3 offset:18432
    v_permlane32_swap_b32 v50, v54
    v_mfma_f32_16x16x32_bf16 v[64:67], a[92:95], v[88:91], v[64:67]
    v_permlane32_swap_b32 v51, v55
    v_mul_f32 v46, v42, v46
    v_mfma_f32_16x16x32_bf16 v[72:75], a[156:159], v[88:91], v[72:75]
    v_mul_f32 v42, v42, v120
    v_mul_f32_e64 v47, v43, v47
    v_mfma_f32_16x16x32_bf16 v[60:63], a[28:31], v[92:95], v[60:63]
    ds_read_b128 a[252:255], v3 offset:18688
    v_exp_f32_e64 v42, v42
    v_mfma_f32_16x16x32_bf16 v[68:71], a[92:95], v[92:95], v[68:71]
    buffer_load_dwordx4 v7, s[48:51], s8 offen offset:1024 sc1 lds
    v_mul_f32 v43, v43, v120
    v_mfma_f32_16x16x32_bf16 v[76:79], a[156:159], v[92:95], v[76:79]
    s_waitcnt lgkmcnt(2)
    v_exp_f32_e64 v43, v43
    v_mfma_f32_16x16x32_bf16 v[56:59], a[32:35], a[240:243], v[56:59]
    ds_read_b128 v[80:83], v3 offset:20480
    v_fma_f32 v42, v42, v124, v124
    v_fma_f32 v43, v43, v124, v124
    v_mfma_f32_16x16x32_bf16 v[64:67], a[96:99], a[240:243], v[64:67]
    v_rcp_f32 v42, v42
    v_mul_f32 v52, v48, v52
    v_mfma_f32_16x16x32_bf16 v[72:75], a[160:163], a[240:243], v[72:75]
    buffer_load_dwordx4 v7, s[48:51], s8 offen offset:2048 sc1 lds
    v_mul_f32_e64 v42, v42, v46
    v_mfma_f32_16x16x32_bf16 v[60:63], a[32:35], a[244:247], v[60:63]
    ds_read_b128 v[84:87], v3 offset:20736
    v_mul_f32 v48, v48, v120
    v_mfma_f32_16x16x32_bf16 v[68:71], a[96:99], a[244:247], v[68:71]
    v_rcp_f32 v43, v43
    v_mul_f32 v53, v49, v53
    v_mfma_f32_16x16x32_bf16 v[76:79], a[160:163], a[244:247], v[76:79]
    s_waitcnt lgkmcnt(2)
    v_exp_f32 v48, v48
    v_mul_f32 v43, v43, v47
    v_mfma_f32_16x16x32_bf16 v[56:59], a[36:39], a[248:251], v[56:59]
    ds_read_b128 v[88:91], v3 offset:22528
    v_cvt_pk_bf16_f32 v111, v42, v43
    v_mfma_f32_16x16x32_bf16 v[64:67], a[100:103], a[248:251], v[64:67]
    buffer_load_dwordx4 v7, s[48:51], s8 offen offset:3072 sc1 lds
    v_mul_f32_e64 v49, v49, v120
    v_mfma_f32_16x16x32_bf16 v[72:75], a[164:167], a[248:251], v[72:75]
    s_nop 0
    v_permlane16_swap_b32 v109, v111
    v_mfma_f32_16x16x32_bf16 v[60:63], a[36:39], a[252:255], v[60:63]
    ds_read_b128 v[92:95], v3 offset:22784
    buffer_store_dwordx4 v[108:111], v116, s[48:51], s5 offen offset:0 sc1
    v_fma_f32 v48, v48, v124, v124
    v_mfma_f32_16x16x32_bf16 v[68:71], a[100:103], a[252:255], v[68:71]
    s_waitcnt vmcnt(9)
    ds_read_b64_tr_b16 v[128:129], v9 offset:32768
    v_exp_f32 v49, v49
    v_mfma_f32_16x16x32_bf16 v[76:79], a[164:167], a[252:255], v[76:79]
    s_waitcnt lgkmcnt(3)
    ds_read_b64_tr_b16 v[130:131], v9 offset:33280
    v_rcp_f32 v48, v48
    v_mfma_f32_16x16x32_bf16 v[56:59], a[40:43], v[80:83], v[56:59]
    ds_read_b128 a[240:243], v3 offset:24576
    v_fma_f32 v49, v49, v124, v124
    v_mul_f32_e64 v48, v48, v52
    v_mfma_f32_16x16x32_bf16 v[64:67], a[104:107], v[80:83], v[64:67]
    ds_read_b64_tr_b16 v[132:133], v8 offset:32768
    v_mul_f32 v54, v50, v54
    v_mfma_f32_16x16x32_bf16 v[72:75], a[168:171], v[80:83], v[72:75]
    s_add_u32 m0, s66, 98304
    s_add_u32 s8, s67, 0
    buffer_load_dwordx4 v2, s[40:43], s8 offen offset:0 lds
    v_mfma_f32_16x16x32_bf16 v[60:63], a[40:43], v[84:87], v[60:63]
    ds_read_b128 a[244:247], v3 offset:24832
    v_rcp_f32_e64 v49, v49
    v_mfma_f32_16x16x32_bf16 v[68:71], a[104:107], v[84:87], v[68:71]
    ds_read_b64_tr_b16 v[134:135], v8 offset:33280
    v_mul_f32 v49, v49, v53
    v_mfma_f32_16x16x32_bf16 v[76:79], a[168:171], v[84:87], v[76:79]
    s_waitcnt lgkmcnt(6)
    ds_read_b64_tr_b16 v[136:137], v5 offset:32768
    v_cvt_pk_bf16_f32 v112, v48, v49
    v_cvt_pk_bf16_f32 v114, v48, v49
    v_mfma_f32_16x16x32_bf16 v[56:59], a[44:47], v[88:91], v[56:59]
    s_nop 0
    ds_read_b128 a[248:251], v3 offset:26624
    v_permlane16_swap_b32 v112, v114
    v_mfma_f32_16x16x32_bf16 v[64:67], a[108:111], v[88:91], v[64:67]
    ds_read_b64_tr_b16 v[138:139], v5 offset:33280
    v_mul_f32_e64 v50, v50, v120
    v_mfma_f32_16x16x32_bf16 v[72:75], a[172:175], v[88:91], v[72:75]
    buffer_load_dwordx4 v6, s[40:43], s8 offen offset:1024 lds
    v_mul_f32_e64 v55, v51, v55
    v_mfma_f32_16x16x32_bf16 v[60:63], a[44:47], v[92:95], v[60:63]
    ds_read_b128 a[252:255], v3 offset:26880
    v_exp_f32_e64 v50, v50
    v_mfma_f32_16x16x32_bf16 v[68:71], a[108:111], v[92:95], v[68:71]
    ds_read_b64_tr_b16 v[140:141], v14 offset:32768
    v_mul_f32_e64 v51, v51, v120
    v_fma_f32 v50, v50, v124, v124
    v_mfma_f32_16x16x32_bf16 v[76:79], a[172:175], v[92:95], v[76:79]
    s_waitcnt lgkmcnt(6)
    ds_read_b64_tr_b16 v[142:143], v14 offset:33280
    v_mul_f32 v121, 0xbb000000, v121
    v_mfma_f32_16x16x32_bf16 v[56:59], a[48:51], a[240:243], v[56:59]
    s_nop 0
    ds_read_b128 v[80:83], v3 offset:28672
    v_exp_f32_e64 v51, v51
    v_mfma_f32_16x16x32_bf16 v[64:67], a[112:115], a[240:243], v[64:67]
    s_add_u32 s8, s67, 14336
    buffer_load_dwordx4 v2, s[40:43], s8 offen offset:2048 lds
    v_fma_f32 v51, v51, v124, v124
    v_mfma_f32_16x16x32_bf16 v[72:75], a[176:179], a[240:243], v[72:75]
    buffer_load_dwordx4 v6, s[40:43], s8 offen offset:3072 lds
    v_mfma_f32_16x16x32_bf16 v[60:63], a[48:51], a[244:247], v[60:63]
    ds_read_b128 v[84:87], v3 offset:28928
    v_rcp_f32 v50, v50
    v_mfma_f32_16x16x32_bf16 v[68:71], a[112:115], a[244:247], v[68:71]
    s_waitcnt vmcnt(9)
    ds_read_b64_tr_b16 v[144:145], v9 offset:36864
    v_rcp_f32_e64 v51, v51
    v_mfma_f32_16x16x32_bf16 v[76:79], a[176:179], a[244:247], v[76:79]
    s_waitcnt lgkmcnt(5)
    v_mul_f32 v50, v50, v54
    v_mul_f32_e64 v51, v51, v55
    v_mfma_f32_16x16x32_bf16 v[56:59], a[52:55], a[248:251], v[56:59]
    ds_read_b128 v[88:91], v3 offset:30720
    v_cvt_pk_bf16_f32 v113, v50, v51
    v_cvt_pk_bf16_f32 v115, v50, v51
    v_mfma_f32_16x16x32_bf16 v[64:67], a[116:119], a[248:251], v[64:67]
    s_nop 0
    ds_read_b64_tr_b16 v[146:147], v9 offset:37376
    v_permlane16_swap_b32 v113, v115
    v_mfma_f32_16x16x32_bf16 v[72:75], a[180:183], a[248:251], v[72:75]
    ds_read_b64_tr_b16 v[148:149], v8 offset:36864
    buffer_store_dwordx4 v[112:115], v11, s[48:51], s5 offen offset:0 sc1
    v_mul_f32 v125, 0x3b000000, v125
    v_mfma_f32_16x16x32_bf16 v[60:63], a[52:55], a[252:255], v[60:63]
    ds_read_b128 v[92:95], v3 offset:30976
    v_cvt_pk_bf16_f32 v98, v121, v121
    v_mfma_f32_16x16x32_bf16 v[68:71], a[116:119], a[252:255], v[68:71]
    ds_read_b64_tr_b16 v[150:151], v8 offset:37376
    v_cvt_pk_bf16_f32 v102, v121, v121
    v_fma_f32 v125, -v121, v121, v125
    v_mfma_f32_16x16x32_bf16 v[76:79], a[180:183], a[252:255], v[76:79]
    s_waitcnt lgkmcnt(6)
    s_add_u32 m0, s66, 102400
    s_add_u32 s8, s68, 0
    buffer_load_dwordx4 v2, s[40:43], s8 offen offset:0 lds
    v_mfma_f32_16x16x32_bf16 v[56:59], a[56:59], v[80:83], v[56:59]
    s_waitcnt vmcnt(7)
    s_barrier
    ds_read_b128 a[240:243], v4 offset:32768
    v_mfma_f32_16x16x32_bf16 v[64:67], a[120:123], v[80:83], v[64:67]
    ds_read_b64_tr_b16 v[152:153], v5 offset:36864
    v_max_f32 v125, 0, v125
    v_mfma_f32_16x16x32_bf16 v[72:75], a[184:187], v[80:83], v[72:75]
    ds_read_b64_tr_b16 v[154:155], v5 offset:37376
    v_permlane32_swap_b32 v98, v102
    v_mfma_f32_16x16x32_bf16 v[60:63], a[56:59], v[84:87], v[60:63]
    ds_read_b128 a[244:247], v4 offset:33024
    v_add_f32 v125, 0x3727c5ac, v125
    v_mfma_f32_16x16x32_bf16 v[68:71], a[120:123], v[84:87], v[68:71]
    ds_read_b64_tr_b16 v[156:157], v14 offset:36864
    v_rsq_f32 v121, v125
    v_mfma_f32_16x16x32_bf16 v[76:79], a[184:187], v[84:87], v[76:79]
    s_waitcnt lgkmcnt(6)
    buffer_load_dwordx4 v6, s[40:43], s8 offen offset:1024 lds
    v_mul_f32 v121, 0xbfb8aa3b, v121
    v_mfma_f32_16x16x32_bf16 v[56:59], a[60:63], v[88:91], v[56:59]
    ds_read_b128 a[248:251], v4 offset:34816
    v_mfma_f32_16x16x32_bf16 v[64:67], a[124:127], v[88:91], v[64:67]
    ds_read_b64_tr_b16 v[158:159], v14 offset:37376
    v_mfma_f32_16x16x32_bf16 v[72:75], a[188:191], v[88:91], v[72:75]
    s_add_u32 s8, s68, 14336
    buffer_load_dwordx4 v2, s[40:43], s8 offen offset:2048 lds
    v_mfma_f32_16x16x32_bf16 v[60:63], a[60:63], v[92:95], v[60:63]
    ds_read_b128 a[252:255], v4 offset:35072
    v_mfma_f32_16x16x32_bf16 v[68:71], a[124:127], v[92:95], v[68:71]
    buffer_load_dwordx4 v6, s[40:43], s8 offen offset:3072 lds
    v_mfma_f32_16x16x32_bf16 v[76:79], a[188:191], v[92:95], v[76:79]
    s_waitcnt lgkmcnt(4)
    v_mfma_f32_16x16x16_bf16 v[56:59], v[96:97], v[98:99], v[56:59]
    s_nop 0
    v_mfma_f32_16x16x16_bf16 v[60:63], v[96:97], v[102:103], v[60:63]
    v_mfma_f32_16x16x16_bf16 v[64:67], v[100:101], v[98:99], v[64:67]
    v_mfma_f32_16x16x16_bf16 v[68:71], v[100:101], v[102:103], v[68:71]
    s_add_u32 m0, s66, 131072
    s_add_u32 s8, s64, 32768
    buffer_load_dwordx4 v2, s[40:43], s8 offen offset:0 lds
    v_mfma_f32_16x16x16_bf16 v[72:75], v[104:105], v[98:99], v[72:75]
    v_mfma_f32_16x16x16_bf16 v[76:79], v[104:105], v[102:103], v[76:79]
    v_mfma_f32_16x16x32_bf16 v[32:35], a[0:3], a[240:243], 0
    ds_read_b128 v[80:83], v4 offset:36864
    v_mfma_f32_16x16x32_bf16 v[40:43], a[64:67], a[240:243], 0
    buffer_load_dwordx4 v6, s[40:43], s8 offen offset:1024 lds
    v_mfma_f32_16x16x32_bf16 v[48:51], a[128:131], a[240:243], 0
    v_mfma_f32_16x16x32_bf16 v[36:39], a[0:3], a[244:247], 0
    ds_read_b128 v[84:87], v4 offset:37120
    v_permlane32_swap_b32 v56, v60
    v_permlane32_swap_b32 v57, v61
    v_mfma_f32_16x16x32_bf16 v[44:47], a[64:67], a[244:247], 0
    v_permlane32_swap_b32 v58, v62
    v_mul_f32 v60, v56, v60
    v_mfma_f32_16x16x32_bf16 v[52:55], a[128:131], a[244:247], 0
    s_waitcnt lgkmcnt(2)
    v_permlane32_swap_b32 v59, v63
    v_mul_f32_e64 v56, v56, v121
    v_mfma_f32_16x16x32_bf16 v[32:35], a[4:7], a[248:251], v[32:35]
    ds_read_b128 v[88:91], v4 offset:38912
    v_exp_f32_e64 v56, v56
    v_mfma_f32_16x16x32_bf16 v[40:43], a[68:71], a[248:251], v[40:43]
    s_add_u32 s8, s64, 47104
    buffer_load_dwordx4 v2, s[40:43], s8 offen offset:2048 lds
    v_mul_f32_e64 v61, v57, v61
    v_mfma_f32_16x16x32_bf16 v[48:51], a[132:135], a[248:251], v[48:51]
    v_mul_f32 v57, v57, v121
    v_exp_f32 v57, v57
    v_mfma_f32_16x16x32_bf16 v[36:39], a[4:7], a[252:255], v[36:39]
    ds_read_b128 v[92:95], v4 offset:39168
    v_fma_f32 v56, v56, v125, v125
    v_fma_f32 v57, v57, v125, v125
    v_mfma_f32_16x16x32_bf16 v[44:47], a[68:71], a[252:255], v[44:47]
    buffer_load_dwordx4 v6, s[40:43], s8 offen offset:3072 lds
    v_mul_f32 v62, v58, v62
    v_mfma_f32_16x16x32_bf16 v[52:55], a[132:135], a[252:255], v[52:55]
    s_waitcnt lgkmcnt(2)
    v_rcp_f32_e64 v56, v56
    v_mul_f32_e64 v58, v58, v121
    v_mfma_f32_16x16x32_bf16 v[32:35], a[8:11], v[80:83], v[32:35]
    ds_read_b128 a[240:243], v4 offset:40960
    v_mul_f32 v56, v56, v60
    v_mfma_f32_16x16x32_bf16 v[40:43], a[72:75], v[80:83], v[40:43]
    s_waitcnt vmcnt(9)
    ds_read_b64_tr_b16 v[160:161], v9 offset:0
    v_rcp_f32_e64 v57, v57
    v_mfma_f32_16x16x32_bf16 v[48:51], a[136:139], v[80:83], v[48:51]
    ds_read_b64_tr_b16 v[162:163], v9 offset:512
    v_exp_f32_e64 v58, v58
    v_mfma_f32_16x16x32_bf16 v[36:39], a[8:11], v[84:87], v[36:39]
    s_nop 0
    ds_read_b128 a[244:247], v4 offset:41216
    v_permlane32_swap_b32 v64, v68
    v_mfma_f32_16x16x32_bf16 v[44:47], a[72:75], v[84:87], v[44:47]
    ds_read_b64_tr_b16 v[164:165], v8 offset:0
    v_permlane32_swap_b32 v65, v69
    v_mfma_f32_16x16x32_bf16 v[52:55], a[136:139], v[84:87], v[52:55]
    s_waitcnt lgkmcnt(5)
    s_add_u32 m0, s66, 135168
    s_add_u32 s8, s65, 32768
    buffer_load_dwordx4 v2, s[40:43], s8 offen offset:0 lds
    v_mfma_f32_16x16x32_bf16 v[32:35], a[12:15], v[88:91], v[32:35]
    ds_read_b128 a[248:251], v4 offset:43008
    v_mul_f32_e64 v57, v57, v61
    v_mfma_f32_16x16x32_bf16 v[40:43], a[76:79], v[88:91], v[40:43]
    ds_read_b64_tr_b16 v[166:167], v8 offset:512
    v_permlane32_swap_b32 v66, v70
    v_mfma_f32_16x16x32_bf16 v[48:51], a[140:143], v[88:91], v[48:51]
    ds_read_b64_tr_b16 v[168:169], v5 offset:0
    v_permlane32_swap_b32 v67, v71
    v_mfma_f32_16x16x32_bf16 v[36:39], a[12:15], v[92:95], v[36:39]
    ds_read_b128 a[252:255], v4 offset:43264
    v_cvt_pk_bf16_f32 v108, v56, v57
    v_mul_f32_e64 v63, v59, v63
    v_mfma_f32_16x16x32_bf16 v[44:47], a[76:79], v[92:95], v[44:47]
    ds_read_b64_tr_b16 v[170:171], v5 offset:512
    v_mul_f32_e64 v59, v59, v121
    v_fma_f32 v58, v58, v125, v125
    v_mfma_f32_16x16x32_bf16 v[52:55], a[140:143], v[92:95], v[52:55]
    s_waitcnt lgkmcnt(6)
    buffer_load_dwordx4 v6, s[40:43], s8 offen offset:1024 lds
    v_mul_f32 v68, v64, v68
    v_mfma_f32_16x16x32_bf16 v[32:35], a[16:19], a[240:243], v[32:35]
    ds_read_b128 v[80:83], v4 offset:45056
    v_exp_f32_e64 v59, v59
    v_mfma_f32_16x16x32_bf16 v[40:43], a[80:83], a[240:243], v[40:43]
    ds_read_b64_tr_b16 v[172:173], v14 offset:0
    v_rcp_f32_e64 v58, v58
    v_mfma_f32_16x16x32_bf16 v[48:51], a[144:147], a[240:243], v[48:51]
    ds_read_b64_tr_b16 v[174:175], v14 offset:512
    v_fma_f32 v59, v59, v125, v125
    v_mul_f32_e64 v58, v58, v62
    v_mfma_f32_16x16x32_bf16 v[36:39], a[16:19], a[244:247], v[36:39]
    ds_read_b128 v[84:87], v4 offset:45312
    v_rcp_f32_e64 v59, v59
    v_mfma_f32_16x16x32_bf16 v[44:47], a[80:83], a[244:247], v[44:47]
    s_add_u32 s8, s65, 47104
    buffer_load_dwordx4 v2, s[40:43], s8 offen offset:2048 lds
    v_mul_f32 v59, v59, v63
    v_mfma_f32_16x16x32_bf16 v[52:55], a[144:147], a[244:247], v[52:55]
    s_waitcnt lgkmcnt(5)
    buffer_load_dwordx4 v6, s[40:43], s8 offen offset:3072 lds
    v_cvt_pk_bf16_f32 v109, v58, v59
    v_mfma_f32_16x16x32_bf16 v[32:35], a[20:23], a[248:251], v[32:35]
    ds_read_b128 v[88:91], v4 offset:47104
    v_mul_f32 v64, v64, v121
    v_mul_f32 v69, v65, v69
    v_mfma_f32_16x16x32_bf16 v[40:43], a[84:87], a[248:251], v[40:43]
    v_exp_f32 v64, v64
    v_mul_f32_e64 v65, v65, v121
    v_mfma_f32_16x16x32_bf16 v[48:51], a[148:151], a[248:251], v[48:51]
    s_waitcnt vmcnt(8)
    ds_read_b64_tr_b16 v[176:177], v9 offset:4096
    v_fma_f32 v64, v64, v125, v125
    v_mfma_f32_16x16x32_bf16 v[36:39], a[20:23], a[252:255], v[36:39]
    ds_read_b128 v[92:95], v4 offset:47360
    v_exp_f32_e64 v65, v65
    v_mfma_f32_16x16x32_bf16 v[44:47], a[84:87], a[252:255], v[44:47]
    ds_read_b64_tr_b16 v[178:179], v9 offset:4608
    v_rcp_f32 v64, v64
    v_mfma_f32_16x16x32_bf16 v[52:55], a[148:151], a[252:255], v[52:55]
    s_waitcnt lgkmcnt(4)
    s_add_u32 m0, s66, 98304
    s_add_u32 s8, s67, 32768
    buffer_load_dwordx4 v2, s[40:43], s8 offen offset:0 lds
    v_mfma_f32_16x16x32_bf16 v[32:35], a[24:27], v[80:83], v[32:35]
    ds_read_b128 a[240:243], v4 offset:49152
    v_fma_f32 v65, v65, v125, v125
    v_mfma_f32_16x16x32_bf16 v[40:43], a[88:91], v[80:83], v[40:43]
    ds_read_b64_tr_b16 v[180:181], v8 offset:4096
    v_rcp_f32_e64 v65, v65
    v_mfma_f32_16x16x32_bf16 v[48:51], a[152:155], v[80:83], v[48:51]
    ds_read_b64_tr_b16 v[182:183], v8 offset:4608
    v_mul_f32 v64, v64, v68
    v_mul_f32 v65, v65, v69
    v_mfma_f32_16x16x32_bf16 v[36:39], a[24:27], v[84:87], v[36:39]
    ds_read_b128 a[244:247], v4 offset:49408
    v_cvt_pk_bf16_f32 v110, v64, v65
    v_mul_f32_e64 v70, v66, v70
    v_mfma_f32_16x16x32_bf16 v[44:47], a[88:91], v[84:87], v[44:47]
    ds_read_b64_tr_b16 v[184:185], v5 offset:4096
    v_permlane16_swap_b32 v108, v110
    v_mfma_f32_16x16x32_bf16 v[52:55], a[152:155], v[84:87], v[52:55]
    s_waitcnt lgkmcnt(6)
    buffer_load_dwordx4 v6, s[40:43], s8 offen offset:1024 lds
    v_mul_f32_e64 v66, v66, v121
    v_mfma_f32_16x16x32_bf16 v[32:35], a[28:31], v[88:91], v[32:35]
    ds_read_b128 a[248:251], v4 offset:51200
    v_exp_f32_e64 v66, v66
    v_mfma_f32_16x16x32_bf16 v[40:43], a[92:95], v[88:91], v[40:43]
    s_nop 0
    ds_read_b64_tr_b16 v[186:187], v5 offset:4608
    v_permlane32_swap_b32 v72, v76
    v_mfma_f32_16x16x32_bf16 v[48:51], a[156:159], v[88:91], v[48:51]
    ds_read_b64_tr_b16 v[188:189], v14 offset:4096
    v_permlane32_swap_b32 v73, v77
    v_mfma_f32_16x16x32_bf16 v[36:39], a[28:31], v[92:95], v[36:39]
    s_nop 0
    ds_read_b128 a[252:255], v4 offset:51456
    v_permlane32_swap_b32 v74, v78
    v_mfma_f32_16x16x32_bf16 v[44:47], a[92:95], v[92:95], v[44:47]
    s_nop 0
    ds_read_b64_tr_b16 v[190:191], v14 offset:4608
    v_permlane32_swap_b32 v75, v79
    v_mfma_f32_16x16x32_bf16 v[52:55], a[156:159], v[92:95], v[52:55]
    s_waitcnt lgkmcnt(6)
    s_add_u32 s8, s67, 47104
    buffer_load_dwordx4 v2, s[40:43], s8 offen offset:2048 lds
    v_mfma_f32_16x16x32_bf16 v[32:35], a[32:35], a[240:243], v[32:35]
    ds_read_b128 v[80:83], v4 offset:53248
    v_mul_f32 v71, v67, v71
    v_mul_f32 v67, v67, v121
    v_mfma_f32_16x16x32_bf16 v[40:43], a[96:99], a[240:243], v[40:43]
    buffer_load_dwordx4 v6, s[40:43], s8 offen offset:3072 lds
    v_fma_f32 v66, v66, v125, v125
    v_mfma_f32_16x16x32_bf16 v[48:51], a[160:163], a[240:243], v[48:51]
    s_waitcnt vmcnt(8)
    ds_read_b64_tr_b16 v[192:193], v9 offset:32768
    v_exp_f32 v67, v67
    v_mfma_f32_16x16x32_bf16 v[36:39], a[32:35], a[244:247], v[36:39]
    ds_read_b128 v[84:87], v4 offset:53504
    v_rcp_f32_e64 v66, v66
    v_mfma_f32_16x16x32_bf16 v[44:47], a[96:99], a[244:247], v[44:47]
    v_fma_f32 v67, v67, v125, v125
    v_mul_f32 v66, v66, v70
    v_mfma_f32_16x16x32_bf16 v[52:55], a[160:163], a[244:247], v[52:55]
    s_waitcnt lgkmcnt(4)
    ds_read_b64_tr_b16 v[194:195], v9 offset:33280
    v_rcp_f32_e64 v67, v67
    v_mfma_f32_16x16x32_bf16 v[32:35], a[36:39], a[248:251], v[32:35]
    ds_read_b128 v[88:91], v4 offset:55296
    v_mul_f32_e64 v67, v67, v71
    v_cvt_pk_bf16_f32 v111, v66, v67
    v_mfma_f32_16x16x32_bf16 v[40:43], a[100:103], a[248:251], v[40:43]
    ds_read_b64_tr_b16 v[196:197], v8 offset:32768
    v_permlane16_swap_b32 v109, v111
    v_mfma_f32_16x16x32_bf16 v[48:51], a[164:167], a[248:251], v[48:51]
    s_waitcnt lgkmcnt(6)
    s_add_u32 m0, s66, 102400
    s_add_u32 s8, s68, 32768
    buffer_load_dwordx4 v2, s[40:43], s8 offen offset:0 lds
    v_mfma_f32_16x16x32_bf16 v[36:39], a[36:39], a[252:255], v[36:39]
    ds_read_b128 v[92:95], v4 offset:55552
    buffer_store_dwordx4 v[108:111], v116, s[48:51], s6 offen offset:0 sc1
    v_mfma_f32_16x16x32_bf16 v[44:47], a[100:103], a[252:255], v[44:47]
    ds_read_b64_tr_b16 v[198:199], v8 offset:33280
    v_mul_f32 v76, v72, v76
    v_mul_f32 v72, v72, v121
    v_mfma_f32_16x16x32_bf16 v[52:55], a[164:167], a[252:255], v[52:55]
    s_waitcnt lgkmcnt(5)
    ds_read_b64_tr_b16 v[200:201], v5 offset:32768
    v_exp_f32 v72, v72
    v_mfma_f32_16x16x32_bf16 v[32:35], a[40:43], v[80:83], v[32:35]
    ds_read_b128 a[240:243], v4 offset:57344
    v_mul_f32 v77, v73, v77
    v_mul_f32 v73, v73, v121
    v_mfma_f32_16x16x32_bf16 v[40:43], a[104:107], v[80:83], v[40:43]
    ds_read_b64_tr_b16 v[202:203], v5 offset:33280
    v_exp_f32_e64 v73, v73
    v_mfma_f32_16x16x32_bf16 v[48:51], a[168:171], v[80:83], v[48:51]
    buffer_load_dwordx4 v6, s[40:43], s8 offen offset:1024 lds
    v_fma_f32 v72, v72, v125, v125
    v_mfma_f32_16x16x32_bf16 v[36:39], a[40:43], v[84:87], v[36:39]
    ds_read_b128 a[244:247], v4 offset:57600
    v_rcp_f32_e64 v72, v72
    v_mfma_f32_16x16x32_bf16 v[44:47], a[104:107], v[84:87], v[44:47]
    ds_read_b64_tr_b16 v[204:205], v14 offset:32768
    v_fma_f32 v73, v73, v125, v125
    v_mul_f32 v72, v72, v76
    v_mfma_f32_16x16x32_bf16 v[52:55], a[168:171], v[84:87], v[52:55]
    s_waitcnt lgkmcnt(6)
    ds_read_b64_tr_b16 v[206:207], v14 offset:33280
    v_rcp_f32_e64 v73, v73
    v_mfma_f32_16x16x32_bf16 v[32:35], a[44:47], v[88:91], v[32:35]
    ds_read_b128 a[248:251], v4 offset:59392
    v_mul_f32_e64 v73, v73, v77
    v_cvt_pk_bf16_f32 v112, v72, v73
    v_mfma_f32_16x16x32_bf16 v[40:43], a[108:111], v[88:91], v[40:43]
    s_add_u32 s8, s68, 47104
    buffer_load_dwordx4 v2, s[40:43], s8 offen offset:2048 lds
    v_cvt_pk_bf16_f32 v114, v72, v73
    v_mfma_f32_16x16x32_bf16 v[48:51], a[172:175], v[88:91], v[48:51]
    buffer_load_dwordx4 v6, s[40:43], s8 offen offset:3072 lds
    v_mul_f32_e64 v78, v74, v78
    v_mfma_f32_16x16x32_bf16 v[36:39], a[44:47], v[92:95], v[36:39]
    ds_read_b128 a[252:255], v4 offset:59648
    v_permlane16_swap_b32 v112, v114
    v_mfma_f32_16x16x32_bf16 v[44:47], a[108:111], v[92:95], v[44:47]
    s_waitcnt vmcnt(9)
    ds_read_b64_tr_b16 v[208:209], v9 offset:36864
    v_mul_f32 v74, v74, v121
    v_mul_f32 v79, v75, v79
    v_mfma_f32_16x16x32_bf16 v[52:55], a[172:175], v[92:95], v[52:55]
    s_waitcnt lgkmcnt(5)
    ds_read_b64_tr_b16 v[210:211], v9 offset:37376
    v_exp_f32 v74, v74
    v_mfma_f32_16x16x32_bf16 v[32:35], a[48:51], a[240:243], v[32:35]
    ds_read_b128 v[80:83], v4 offset:61440
    v_mul_f32_e64 v75, v75, v121
    v_mfma_f32_16x16x32_bf16 v[40:43], a[112:115], a[240:243], v[40:43]
    ds_read_b64_tr_b16 v[212:213], v8 offset:36864
    v_exp_f32 v75, v75
    v_mfma_f32_16x16x32_bf16 v[48:51], a[176:179], a[240:243], v[48:51]
    s_waitcnt lgkmcnt(6)
    s_add_u32 m0, s66, 131072
    s_add_u32 s8, s69, 65536
    buffer_load_dwordx4 v2, s[40:43], s8 offen offset:0 lds
    v_mfma_f32_16x16x32_bf16 v[36:39], a[48:51], a[244:247], v[36:39]
    ds_read_b128 v[84:87], v4 offset:61696
    v_fma_f32 v74, v74, v125, v125
    v_mfma_f32_16x16x32_bf16 v[44:47], a[112:115], a[244:247], v[44:47]
    ds_read_b64_tr_b16 v[214:215], v8 offset:37376
    v_rcp_f32 v74, v74
    v_mfma_f32_16x16x32_bf16 v[52:55], a[176:179], a[244:247], v[52:55]
    s_waitcnt lgkmcnt(6)
    ds_read_b64_tr_b16 v[216:217], v5 offset:36864
    v_fma_f32 v75, v75, v125, v125
    v_mul_f32_e64 v74, v74, v78
    v_mfma_f32_16x16x32_bf16 v[32:35], a[52:55], a[248:251], v[32:35]
    ds_read_b128 v[88:91], v4 offset:63488
    v_rcp_f32_e64 v75, v75
    v_mfma_f32_16x16x32_bf16 v[40:43], a[116:119], a[248:251], v[40:43]
    ds_read_b64_tr_b16 v[218:219], v5 offset:37376
    v_mul_f32_e64 v75, v75, v79
    v_cvt_pk_bf16_f32 v113, v74, v75
    v_mfma_f32_16x16x32_bf16 v[48:51], a[180:183], a[248:251], v[48:51]
    buffer_load_dwordx4 v6, s[40:43], s8 offen offset:1024 lds
    v_cvt_pk_bf16_f32 v115, v74, v75
    v_mfma_f32_16x16x32_bf16 v[36:39], a[52:55], a[252:255], v[36:39]
    s_nop 0
    ds_read_b128 v[92:95], v4 offset:63744
    v_permlane16_swap_b32 v113, v115
    v_mfma_f32_16x16x32_bf16 v[44:47], a[116:119], a[252:255], v[44:47]
    ds_read_b64_tr_b16 v[220:221], v14 offset:36864
    buffer_store_dwordx4 v[112:115], v11, s[48:51], s6 offen offset:0 sc1
    v_mul_f32 v122, 0xbb000000, v122
    v_mfma_f32_16x16x32_bf16 v[52:55], a[180:183], a[252:255], v[52:55]
    s_waitcnt lgkmcnt(6)
    s_nop 0
    ds_read_b64_tr_b16 v[222:223], v14 offset:37376
    v_mul_f32 v126, 0x3b000000, v126
    v_cvt_pk_bf16_f32 v98, v122, v122
    v_mfma_f32_16x16x32_bf16 v[32:35], a[56:59], v[80:83], v[32:35]
    ds_read_b128 a[240:243], v4 offset:0
    v_cvt_pk_bf16_f32 v102, v122, v122
    v_fma_f32 v126, -v122, v122, v126
    v_mfma_f32_16x16x32_bf16 v[40:43], a[120:123], v[80:83], v[40:43]
    s_add_u32 s8, s69, 79872
    buffer_load_dwordx4 v2, s[40:43], s8 offen offset:2048 lds
    v_max_f32_e64 v126, 0, v126
    v_mfma_f32_16x16x32_bf16 v[48:51], a[184:187], v[80:83], v[48:51]
    buffer_load_dwordx4 v6, s[40:43], s8 offen offset:3072 lds
    v_add_f32 v126, 0x3727c5ac, v126
    v_mfma_f32_16x16x32_bf16 v[36:39], a[56:59], v[84:87], v[36:39]
    ds_read_b128 a[244:247], v4 offset:256
    v_permlane32_swap_b32 v98, v102
    v_mfma_f32_16x16x32_bf16 v[44:47], a[120:123], v[84:87], v[44:47]
    s_waitcnt vmcnt(10)
    ds_read_b64_tr_b16 v[224:225], v9 offset:0
    v_rsq_f32_e64 v122, v126
    v_mfma_f32_16x16x32_bf16 v[52:55], a[184:187], v[84:87], v[52:55]
    s_waitcnt lgkmcnt(5)
    v_mul_f32 v122, 0xbfb8aa3b, v122
    v_mfma_f32_16x16x32_bf16 v[32:35], a[60:63], v[88:91], v[32:35]
L_pad5:
    s_cbranch_execz L_back
    ds_read_b128 a[248:251], v4 offset:2048
    v_mfma_f32_16x16x32_bf16 v[40:43], a[124:127], v[88:91], v[40:43]
    ds_read_b64_tr_b16 v[226:227], v9 offset:512
    v_mfma_f32_16x16x32_bf16 v[48:51], a[188:191], v[88:91], v[48:51]
    ds_read_b64_tr_b16 v[228:229], v8 offset:0
    v_mfma_f32_16x16x32_bf16 v[36:39], a[60:63], v[92:95], v[36:39]
    ds_read_b128 a[252:255], v4 offset:2304
    v_mfma_f32_16x16x32_bf16 v[44:47], a[124:127], v[92:95], v[44:47]
    s_nop 0
    ds_read_b64_tr_b16 v[230:231], v8 offset:512
    v_mfma_f32_16x16x32_bf16 v[52:55], a[188:191], v[92:95], v[52:55]
    s_waitcnt lgkmcnt(6)
    s_add_u32 m0, s66, 135168
    s_add_u32 s8, s69, 458752
    buffer_load_dwordx4 v2, s[40:43], s8 offen offset:0 lds
    v_mfma_f32_16x16x16_bf16 v[32:35], v[96:97], v[98:99], v[32:35]
    ds_read_b64_tr_b16 v[232:233], v5 offset:0
    v_mfma_f32_16x16x16_bf16 v[36:39], v[96:97], v[102:103], v[36:39]
    buffer_load_dwordx4 v6, s[40:43], s8 offen offset:1024 lds
    v_mfma_f32_16x16x16_bf16 v[40:43], v[100:101], v[98:99], v[40:43]
    ds_read_b64_tr_b16 v[234:235], v5 offset:512
    v_mfma_f32_16x16x16_bf16 v[44:47], v[100:101], v[102:103], v[44:47]
    v_mfma_f32_16x16x16_bf16 v[48:51], v[104:105], v[98:99], v[48:51]
    ds_read_b64_tr_b16 v[236:237], v14 offset:0
    v_mfma_f32_16x16x16_bf16 v[52:55], v[104:105], v[102:103], v[52:55]
    s_add_u32 s8, s69, 473088
    buffer_load_dwordx4 v2, s[40:43], s8 offen offset:2048 lds
    v_mfma_f32_16x16x32_bf16 v[56:59], a[0:3], a[240:243], 0
    ds_read_b128 v[80:83], v4 offset:4096
    v_mfma_f32_16x16x32_bf16 v[64:67], a[64:67], a[240:243], 0
    ds_read_b64_tr_b16 v[238:239], v14 offset:512
    v_mfma_f32_16x16x32_bf16 v[72:75], a[128:131], a[240:243], 0
    v_mfma_f32_16x16x32_bf16 v[60:63], a[0:3], a[244:247], 0
    s_nop 0
    ds_read_b128 v[84:87], v4 offset:4352
    v_permlane32_swap_b32 v32, v36
    v_permlane32_swap_b32 v33, v37
    v_mfma_f32_16x16x32_bf16 v[68:71], a[64:67], a[244:247], 0
    s_nop 0
    buffer_load_dwordx4 v6, s[40:43], s8 offen offset:3072 lds
    v_mfma_f32_16x16x32_bf16 v[76:79], a[128:131], a[244:247], 0
    s_waitcnt lgkmcnt(7)
    v_permlane32_swap_b32 v34, v38
    v_mul_f32_e64 v36, v32, v36
    v_mfma_f32_16x16x32_bf16 v[56:59], a[4:7], a[248:251], v[56:59]
    ds_read_b128 v[88:91], v4 offset:6144
    v_permlane32_swap_b32 v35, v39
    v_mfma_f32_16x16x32_bf16 v[64:67], a[68:71], a[248:251], v[64:67]
    s_waitcnt vmcnt(9)
    ds_read_b64_tr_b16 v[240:241], v9 offset:4096
    v_mul_f32_e64 v32, v32, v122
    v_mfma_f32_16x16x32_bf16 v[72:75], a[132:135], a[248:251], v[72:75]
    ds_read_b64_tr_b16 v[242:243], v9 offset:4608
    v_exp_f32_e64 v32, v32
    v_mfma_f32_16x16x32_bf16 v[60:63], a[4:7], a[252:255], v[60:63]
    ds_read_b128 v[92:95], v4 offset:6400
    v_mul_f32 v37, v33, v37
    v_mul_f32 v33, v33, v122
    v_mfma_f32_16x16x32_bf16 v[68:71], a[68:71], a[252:255], v[68:71]
    ds_read_b64_tr_b16 v[244:245], v8 offset:4096
    v_exp_f32 v33, v33
    v_mfma_f32_16x16x32_bf16 v[76:79], a[132:135], a[252:255], v[76:79]
    s_waitcnt lgkmcnt(5)
    s_add_u32 m0, s66, 98304
    s_add_u32 s8, s69, 851968
    buffer_load_dwordx4 v2, s[40:43], s8 offen offset:0 lds
    v_mfma_f32_16x16x32_bf16 v[56:59], a[8:11], v[80:83], v[56:59]
    ds_read_b128 a[240:243], v4 offset:8192
    v_mfma_f32_16x16x32_bf16 v[64:67], a[72:75], v[80:83], v[64:67]
    ds_read_b64_tr_b16 v[246:247], v8 offset:4608
    v_fma_f32 v32, v32, v126, v126
    v_fma_f32 v33, v33, v126, v126
    v_mfma_f32_16x16x32_bf16 v[72:75], a[136:139], v[80:83], v[72:75]
    ds_read_b64_tr_b16 v[248:249], v5 offset:4096
    v_mul_f32_e64 v38, v34, v38
    v_mfma_f32_16x16x32_bf16 v[60:63], a[8:11], v[84:87], v[60:63]
    ds_read_b128 a[244:247], v4 offset:8448
    v_rcp_f32_e64 v32, v32
    v_mfma_f32_16x16x32_bf16 v[68:71], a[72:75], v[84:87], v[68:71]
    ds_read_b64_tr_b16 v[250:251], v5 offset:4608
    v_rcp_f32 v33, v33
    v_mfma_f32_16x16x32_bf16 v[76:79], a[136:139], v[84:87], v[76:79]
    s_waitcnt lgkmcnt(6)
    buffer_load_dwordx4 v6, s[40:43], s8 offen offset:1024 lds
    v_mfma_f32_16x16x32_bf16 v[56:59], a[12:15], v[88:91], v[56:59]
    ds_read_b128 a[248:251], v4 offset:10240
    v_permlane32_swap_b32 v40, v44
    v_mfma_f32_16x16x32_bf16 v[64:67], a[76:79], v[88:91], v[64:67]
    s_nop 0
    ds_read_b64_tr_b16 v[252:253], v14 offset:4096
    v_permlane32_swap_b32 v41, v45
    v_mfma_f32_16x16x32_bf16 v[72:75], a[140:143], v[88:91], v[72:75]
    s_waitcnt vmcnt(8)
    s_atomic_add s62, s[22:23], s27 offset:32768
    s_atomic_add s62, s[22:23], s19 offset:32768
    ds_read_b64_tr_b16 v[254:255], v14 offset:4608
    v_mfma_f32_16x16x32_bf16 v[60:63], a[12:15], v[92:95], v[60:63]
    ds_read_b128 a[252:255], v4 offset:10496
    v_mul_f32_e64 v32, v32, v36
    v_mfma_f32_16x16x32_bf16 v[68:71], a[76:79], v[92:95], v[68:71]
    s_add_u32 s8, s69, 866304
    buffer_load_dwordx4 v2, s[40:43], s8 offen offset:2048 lds
    v_mul_f32 v33, v33, v37
    v_mfma_f32_16x16x32_bf16 v[76:79], a[140:143], v[92:95], v[76:79]
    s_waitcnt lgkmcnt(5)
    buffer_load_dwordx4 v6, s[40:43], s8 offen offset:3072 lds
    v_cvt_pk_bf16_f32 v108, v32, v33
    v_mfma_f32_16x16x32_bf16 v[56:59], a[16:19], a[240:243], v[56:59]
    ds_read_b128 v[80:83], v4 offset:12288
    v_mul_f32 v34, v34, v122
    v_mfma_f32_16x16x32_bf16 v[64:67], a[80:83], a[240:243], v[64:67]
    s_waitcnt vmcnt(8)
    ds_read_b64_tr_b16 a[192:193], v9 offset:32768
    v_exp_f32_e64 v34, v34
    v_mfma_f32_16x16x32_bf16 v[72:75], a[144:147], a[240:243], v[72:75]
    ds_read_b64_tr_b16 a[194:195], v9 offset:33280
    v_permlane32_swap_b32 v42, v46
    v_mfma_f32_16x16x32_bf16 v[60:63], a[16:19], a[244:247], v[60:63]
    s_nop 0
    ds_read_b128 v[84:87], v4 offset:12544
    v_mul_f32_e64 v39, v35, v39
    v_mfma_f32_16x16x32_bf16 v[68:71], a[80:83], a[244:247], v[68:71]
    ds_read_b64_tr_b16 a[196:197], v8 offset:32768
    v_permlane32_swap_b32 v43, v47
    v_mfma_f32_16x16x32_bf16 v[76:79], a[144:147], a[244:247], v[76:79]
    s_waitcnt lgkmcnt(5)
    v_mul_f32 v35, v35, v122
    v_exp_f32 v35, v35
    v_mfma_f32_16x16x32_bf16 v[56:59], a[20:23], a[248:251], v[56:59]
    ds_read_b128 v[88:91], v4 offset:14336
    v_fma_f32 v34, v34, v126, v126
    v_fma_f32 v35, v35, v126, v126
    v_mfma_f32_16x16x32_bf16 v[64:67], a[84:87], a[248:251], v[64:67]
    ds_read_b64_tr_b16 a[198:199], v8 offset:33280
    v_mul_f32_e64 v44, v40, v44
    v_mfma_f32_16x16x32_bf16 v[72:75], a[148:151], a[248:251], v[72:75]
    ds_read_b64_tr_b16 a[200:201], v5 offset:32768
    v_rcp_f32_e64 v34, v34
    v_mfma_f32_16x16x32_bf16 v[60:63], a[20:23], a[252:255], v[60:63]
    ds_read_b128 v[92:95], v4 offset:14592
    v_rcp_f32_e64 v35, v35
    v_mfma_f32_16x16x32_bf16 v[68:71], a[84:87], a[252:255], v[68:71]
    ds_read_b64_tr_b16 a[202:203], v5 offset:33280
    v_mul_f32 v34, v34, v38
    v_mfma_f32_16x16x32_bf16 v[76:79], a[148:151], a[252:255], v[76:79]
    s_waitcnt lgkmcnt(6)
    v_mul_f32 v35, v35, v39
    v_cvt_pk_bf16_f32 v109, v34, v35
    v_mul_f32 v40, v40, v122
    v_mfma_f32_16x16x32_bf16 v[56:59], a[24:27], v[80:83], v[56:59]
    ds_read_b128 a[240:243], v4 offset:16384
    v_exp_f32_e64 v40, v40
    v_mfma_f32_16x16x32_bf16 v[64:67], a[88:91], v[80:83], v[64:67]
    ds_read_b64_tr_b16 a[204:205], v14 offset:32768
    v_mul_f32_e64 v45, v41, v45
    v_mfma_f32_16x16x32_bf16 v[72:75], a[152:155], v[80:83], v[72:75]
    ds_read_b64_tr_b16 a[206:207], v14 offset:33280
    v_mul_f32_e64 v41, v41, v122
    v_fma_f32 v40, v40, v126, v126
    v_mfma_f32_16x16x32_bf16 v[60:63], a[24:27], v[84:87], v[60:63]
    ds_read_b128 a[244:247], v4 offset:16640
    v_exp_f32 v41, v41
    v_mfma_f32_16x16x32_bf16 v[68:71], a[88:91], v[84:87], v[68:71]
    v_rcp_f32 v40, v40
    v_fma_f32 v41, v41, v126, v126
    v_mfma_f32_16x16x32_bf16 v[76:79], a[152:155], v[84:87], v[76:79]
    s_waitcnt lgkmcnt(5)
    v_rcp_f32 v41, v41
    v_mfma_f32_16x16x32_bf16 v[56:59], a[28:31], v[88:91], v[56:59]
    ds_read_b128 a[248:251], v4 offset:18432
    v_mul_f32_e64 v40, v40, v44
    v_mul_f32 v41, v41, v45
    v_mfma_f32_16x16x32_bf16 v[64:67], a[92:95], v[88:91], v[64:67]
    s_waitcnt vmcnt(4)
    ds_read_b64_tr_b16 a[208:209], v9 offset:36864
    v_cvt_pk_bf16_f32 v110, v40, v41
    v_mul_f32_e64 v46, v42, v46
    v_mfma_f32_16x16x32_bf16 v[72:75], a[156:159], v[88:91], v[72:75]
    s_nop 0
    v_permlane16_swap_b32 v108, v110
    v_mfma_f32_16x16x32_bf16 v[60:63], a[28:31], v[92:95], v[60:63]
    s_nop 0
    ds_read_b128 a[252:255], v4 offset:18688
    v_permlane32_swap_b32 v48, v52
    v_mfma_f32_16x16x32_bf16 v[68:71], a[92:95], v[92:95], v[68:71]
    ds_read_b64_tr_b16 a[210:211], v9 offset:37376
    v_permlane32_swap_b32 v49, v53
    v_mfma_f32_16x16x32_bf16 v[76:79], a[156:159], v[92:95], v[76:79]
    s_waitcnt lgkmcnt(4)
    ds_read_b64_tr_b16 a[212:213], v8 offset:36864
    v_mul_f32_e64 v42, v42, v122
    v_mfma_f32_16x16x32_bf16 v[56:59], a[32:35], a[240:243], v[56:59]
    ds_read_b128 v[80:83], v4 offset:20480
    v_exp_f32_e64 v42, v42
    v_mfma_f32_16x16x32_bf16 v[64:67], a[96:99], a[240:243], v[64:67]
    s_nop 0
    ds_read_b64_tr_b16 a[214:215], v8 offset:37376
    v_permlane32_swap_b32 v50, v54
    v_mfma_f32_16x16x32_bf16 v[72:75], a[160:163], a[240:243], v[72:75]
    v_permlane32_swap_b32 v51, v55
    v_mul_f32 v47, v43, v47
    v_mfma_f32_16x16x32_bf16 v[60:63], a[32:35], a[244:247], v[60:63]
    ds_read_b128 v[84:87], v4 offset:20736
    v_mul_f32 v43, v43, v122
    v_mfma_f32_16x16x32_bf16 v[68:71], a[96:99], a[244:247], v[68:71]
    s_mov_b32 s1, 0
    s_atomic_add s1, s[22:23], s61 offset:32768 glc
    ds_read_b64_tr_b16 a[216:217], v5 offset:36864
    v_fma_f32 v42, v42, v126, v126
    v_mfma_f32_16x16x32_bf16 v[76:79], a[160:163], a[244:247], v[76:79]
    s_waitcnt lgkmcnt(6)
    ds_read_b64_tr_b16 a[218:219], v5 offset:37376
    v_exp_f32 v43, v43
    v_mfma_f32_16x16x32_bf16 v[56:59], a[36:39], a[248:251], v[56:59]
    ds_read_b128 v[88:91], v4 offset:22528
    v_fma_f32 v43, v43, v126, v126
    v_mfma_f32_16x16x32_bf16 v[64:67], a[100:103], a[248:251], v[64:67]
    ds_read_b64_tr_b16 a[220:221], v14 offset:36864
    v_rcp_f32_e64 v42, v42
    v_mfma_f32_16x16x32_bf16 v[72:75], a[164:167], a[248:251], v[72:75]
    v_rcp_f32 v43, v43
    v_mul_f32 v42, v42, v46
    v_mfma_f32_16x16x32_bf16 v[60:63], a[36:39], a[252:255], v[60:63]
    ds_read_b128 v[92:95], v4 offset:22784
    v_mul_f32_e64 v43, v43, v47
    v_mfma_f32_16x16x32_bf16 v[68:71], a[100:103], a[252:255], v[68:71]
    ds_read_b64_tr_b16 a[222:223], v14 offset:37376
    v_cvt_pk_bf16_f32 v111, v42, v43
    v_mul_f32_e64 v52, v48, v52
    v_mfma_f32_16x16x32_bf16 v[76:79], a[164:167], a[252:255], v[76:79]
    s_waitcnt lgkmcnt(6)
    v_permlane16_swap_b32 v109, v111
    v_mfma_f32_16x16x32_bf16 v[56:59], a[40:43], v[80:83], v[56:59]
    ds_read_b128 a[240:243], v4 offset:24576
    buffer_store_dwordx4 v[108:111], v116, s[48:51], s5 offen offset:1024 sc1
    v_mul_f32 v48, v48, v122
    v_mul_f32 v53, v49, v53
    v_mfma_f32_16x16x32_bf16 v[64:67], a[104:107], v[80:83], v[64:67]
    v_exp_f32 v48, v48
    v_mfma_f32_16x16x32_bf16 v[72:75], a[168:171], v[80:83], v[72:75]
    v_mul_f32 v49, v49, v122
    v_exp_f32_e64 v49, v49
    v_mfma_f32_16x16x32_bf16 v[60:63], a[40:43], v[84:87], v[60:63]
    ds_read_b128 a[244:247], v4 offset:24832
    v_fma_f32 v48, v48, v126, v126
    v_fma_f32 v49, v49, v126, v126
    v_mfma_f32_16x16x32_bf16 v[68:71], a[104:107], v[84:87], v[68:71]
    s_waitcnt vmcnt(1)
    ds_read_b64_tr_b16 a[224:225], v9 offset:0
    v_mul_f32 v54, v50, v54
    v_mfma_f32_16x16x32_bf16 v[76:79], a[168:171], v[84:87], v[76:79]
    s_waitcnt lgkmcnt(4)
    ds_read_b64_tr_b16 a[226:227], v9 offset:512
    v_rcp_f32 v48, v48
    v_mfma_f32_16x16x32_bf16 v[56:59], a[44:47], v[88:91], v[56:59]
    ds_read_b128 a[248:251], v4 offset:26624
    v_rcp_f32_e64 v49, v49
    v_mfma_f32_16x16x32_bf16 v[64:67], a[108:111], v[88:91], v[64:67]
    ds_read_b64_tr_b16 a[228:229], v8 offset:0
    v_mul_f32 v48, v48, v52
    v_mfma_f32_16x16x32_bf16 v[72:75], a[172:175], v[88:91], v[72:75]
    v_mul_f32 v49, v49, v53
    v_cvt_pk_bf16_f32 v112, v48, v49
    v_cvt_pk_bf16_f32 v114, v48, v49
    v_mfma_f32_16x16x32_bf16 v[60:63], a[44:47], v[92:95], v[60:63]
    ds_read_b128 a[252:255], v4 offset:26880
    v_permlane16_swap_b32 v112, v114
    v_mfma_f32_16x16x32_bf16 v[68:71], a[108:111], v[92:95], v[68:71]
    s_cmp_eq_u32 s1, 16
    s_cbranch_scc0 L_slow_28
L_ok_27:
    ds_read_b64_tr_b16 a[230:231], v8 offset:512
    v_mul_f32_e64 v50, v50, v122
    v_mfma_f32_16x16x32_bf16 v[76:79], a[172:175], v[92:95], v[76:79]
    s_waitcnt lgkmcnt(6)
    ds_read_b64_tr_b16 a[232:233], v5 offset:0
    v_mul_f32_e64 v55, v51, v55
    v_mfma_f32_16x16x32_bf16 v[56:59], a[48:51], a[240:243], v[56:59]
    ds_read_b128 v[80:83], v4 offset:28672
    v_exp_f32_e64 v50, v50
    v_mfma_f32_16x16x32_bf16 v[64:67], a[112:115], a[240:243], v[64:67]
    ds_read_b64_tr_b16 a[234:235], v5 offset:512
    v_mul_f32 v51, v51, v122
    v_fma_f32 v50, v50, v126, v126
    v_mfma_f32_16x16x32_bf16 v[72:75], a[176:179], a[240:243], v[72:75]
    s_xor_b32 s58, s71, 0
    buffer_load_dwordx4 a[0:3], v15, s[48:51], s58 offen offset:0 sc1
    v_mfma_f32_16x16x32_bf16 v[60:63], a[48:51], a[244:247], v[60:63]
    ds_read_b128 v[84:87], v4 offset:28928
    v_exp_f32_e64 v51, v51
    v_mfma_f32_16x16x32_bf16 v[68:71], a[112:115], a[244:247], v[68:71]
    ds_read_b64_tr_b16 a[236:237], v14 offset:0
    v_rcp_f32 v50, v50
    v_mfma_f32_16x16x32_bf16 v[76:79], a[176:179], a[244:247], v[76:79]
    s_waitcnt lgkmcnt(6)
    ds_read_b64_tr_b16 a[238:239], v14 offset:512
    v_fma_f32 v51, v51, v126, v126
    v_mfma_f32_16x16x32_bf16 v[56:59], a[52:55], a[248:251], v[56:59]
    ds_read_b128 v[88:91], v4 offset:30720
    v_rcp_f32_e64 v51, v51
    v_mfma_f32_16x16x32_bf16 v[64:67], a[116:119], a[248:251], v[64:67]
    buffer_load_dwordx4 a[64:67], v15, s[48:51], s58 offen offset:256 sc1
    v_mul_f32_e64 v50, v50, v54
    v_mfma_f32_16x16x32_bf16 v[72:75], a[180:183], a[248:251], v[72:75]
    s_xor_b32 s58, s71, 32768
    buffer_load_dwordx4 a[128:131], v15, s[48:51], s58 offen offset:0 sc1
    v_mul_f32_e64 v51, v51, v55
    v_mfma_f32_16x16x32_bf16 v[60:63], a[52:55], a[252:255], v[60:63]
    ds_read_b128 v[92:95], v4 offset:30976
    v_cvt_pk_bf16_f32 v113, v50, v51
    v_mfma_f32_16x16x32_bf16 v[68:71], a[116:119], a[252:255], v[68:71]
    s_nop 0
    v_cvt_pk_bf16_f32 v115, v50, v51
    s_nop 1
    v_permlane16_swap_b32 v113, v115
    v_mfma_f32_16x16x32_bf16 v[76:79], a[180:183], a[252:255], v[76:79]
    s_waitcnt lgkmcnt(4)
    buffer_load_dwordx4 a[4:7], v15, s[48:51], s58 offen offset:256 sc1
    v_mfma_f32_16x16x32_bf16 v[56:59], a[56:59], v[80:83], v[56:59]
    buffer_store_dwordx4 v[112:115], v11, s[48:51], s5 offen offset:1024 sc1
    v_mul_f32 v123, 0xbb000000, v123
    v_mul_f32 v127, 0x3b000000, v127
    v_mfma_f32_16x16x32_bf16 v[64:67], a[120:123], v[80:83], v[64:67]
    v_cvt_pk_bf16_f32 v98, v123, v123
    v_cvt_pk_bf16_f32 v102, v123, v123
    v_fma_f32 v127, -v123, v123, v127
    v_mfma_f32_16x16x32_bf16 v[72:75], a[184:187], v[80:83], v[72:75]
    v_permlane32_swap_b32 v98, v102
    v_max_f32 v127, 0, v127
    v_mfma_f32_16x16x32_bf16 v[60:63], a[56:59], v[84:87], v[60:63]
    v_add_f32 v127, 0x3727c5ac, v127
    v_mfma_f32_16x16x32_bf16 v[68:71], a[120:123], v[84:87], v[68:71]
    s_xor_b32 s58, s71, 65536
    buffer_load_dwordx4 a[68:71], v15, s[48:51], s58 offen offset:0 sc1
    v_rsq_f32 v123, v127
    v_mfma_f32_16x16x32_bf16 v[76:79], a[184:187], v[84:87], v[76:79]
    s_waitcnt lgkmcnt(0)
    v_mul_f32 v123, 0xbfb8aa3b, v123
    v_mfma_f32_16x16x32_bf16 v[56:59], a[60:63], v[88:91], v[56:59]
    v_mfma_f32_16x16x32_bf16 v[64:67], a[124:127], v[88:91], v[64:67]
    buffer_load_dwordx4 a[132:135], v15, s[48:51], s58 offen offset:256 sc1
    v_mfma_f32_16x16x32_bf16 v[72:75], a[188:191], v[88:91], v[72:75]
    v_mfma_f32_16x16x32_bf16 v[60:63], a[60:63], v[92:95], v[60:63]
    v_mfma_f32_16x16x32_bf16 v[68:71], a[124:127], v[92:95], v[68:71]
    s_xor_b32 s58, s71, 98304
    buffer_load_dwordx4 a[8:11], v15, s[48:51], s58 offen offset:0 sc1
    v_mfma_f32_16x16x32_bf16 v[76:79], a[188:191], v[92:95], v[76:79]
    v_mfma_f32_16x16x16_bf16 v[56:59], v[96:97], v[98:99], v[56:59]
    v_mfma_f32_16x16x16_bf16 v[60:63], v[96:97], v[102:103], v[60:63]
    v_mfma_f32_16x16x16_bf16 v[64:67], v[100:101], v[98:99], v[64:67]
    buffer_load_dwordx4 a[72:75], v15, s[48:51], s58 offen offset:256 sc1
    v_mfma_f32_16x16x16_bf16 v[68:71], v[100:101], v[102:103], v[68:71]
    v_mfma_f32_16x16x16_bf16 v[72:75], v[104:105], v[98:99], v[72:75]
    v_mfma_f32_16x16x16_bf16 v[76:79], v[104:105], v[102:103], v[76:79]
    s_xor_b32 s58, s71, 131072
    buffer_load_dwordx4 a[136:139], v15, s[48:51], s58 offen offset:0 sc1
    s_nop 0
    v_permlane32_swap_b32 v56, v60
    v_permlane32_swap_b32 v57, v61
    v_permlane32_swap_b32 v58, v62
    v_permlane32_swap_b32 v59, v63
    v_mul_f32 v60, v56, v60
    v_mul_f32 v56, v56, v123
    v_mul_f32 v61, v57, v61
    v_mul_f32 v57, v57, v123
    v_exp_f32 v56, v56
    v_exp_f32_e64 v57, v57
    v_fma_f32 v56, v56, v127, v127
    v_fma_f32 v57, v57, v127, v127
    v_rcp_f32 v56, v56
    v_rcp_f32 v57, v57
    v_mul_f32 v56, v56, v60
    v_mul_f32 v57, v57, v61
    v_cvt_pk_bf16_f32 v108, v56, v57
    v_mul_f32 v62, v58, v62
    v_mul_f32 v58, v58, v123
    v_mul_f32 v63, v59, v63
    v_mul_f32 v59, v59, v123
    v_exp_f32 v58, v58
    v_exp_f32 v59, v59
    v_fma_f32 v58, v58, v127, v127
    v_fma_f32 v59, v59, v127, v127
    v_rcp_f32 v58, v58
    v_rcp_f32 v59, v59
    v_mul_f32 v58, v58, v62
    v_mul_f32 v59, v59, v63
    v_cvt_pk_bf16_f32 v109, v58, v59
    v_permlane32_swap_b32 v64, v68
    v_permlane32_swap_b32 v65, v69
    v_permlane32_swap_b32 v66, v70
    v_permlane32_swap_b32 v67, v71
    v_mul_f32 v68, v64, v68
    v_mul_f32 v64, v64, v123
    v_mul_f32 v69, v65, v69
    v_mul_f32 v65, v65, v123
    v_exp_f32 v64, v64
    v_exp_f32 v65, v65
    v_fma_f32 v64, v64, v127, v127
    v_fma_f32 v65, v65, v127, v127
    v_rcp_f32 v64, v64
    v_rcp_f32 v65, v65
    v_mul_f32 v64, v64, v68
    v_mul_f32 v65, v65, v69
    v_cvt_pk_bf16_f32 v110, v64, v65
    v_mul_f32 v70, v66, v70
    v_mul_f32 v66, v66, v123
    v_mul_f32 v71, v67, v71
    v_mul_f32 v67, v67, v123
    v_exp_f32 v66, v66
    v_exp_f32 v67, v67
    v_fma_f32 v66, v66, v127, v127
    v_fma_f32 v67, v67, v127, v127
    v_rcp_f32 v66, v66
    v_rcp_f32 v67, v67
    v_mul_f32 v66, v66, v70
    v_mul_f32 v67, v67, v71
    v_cvt_pk_bf16_f32 v111, v66, v67
    s_waitcnt vmcnt(9)
    v_mfma_f32_16x16x32_bf16 v[16:19], v[128:131], a[0:3], v[16:19]
    v_permlane16_swap_b32 v108, v110
    v_mfma_f32_16x16x32_bf16 v[32:35], v[132:135], a[0:3], 0
    s_nop 0
    v_permlane16_swap_b32 v109, v111
    v_mfma_f32_16x16x32_bf16 v[40:43], v[136:139], a[0:3], 0
    buffer_store_dwordx4 v[108:111], v116, s[48:51], s6 offen offset:1024 sc1
    v_permlane32_swap_b32 v72, v76
    v_mfma_f32_16x16x32_bf16 v[48:51], v[140:143], a[0:3], 0
    s_nop 0
    buffer_load_dwordx4 a[12:15], v15, s[48:51], s58 offen offset:256 sc1
    v_permlane32_swap_b32 v73, v77
    s_waitcnt vmcnt(10)
    v_mfma_f32_16x16x32_bf16 v[20:23], v[128:131], a[64:67], v[20:23]
    s_nop 0
    v_permlane32_swap_b32 v74, v78
    v_mfma_f32_16x16x32_bf16 v[36:39], v[132:135], a[64:67], 0
    v_permlane32_swap_b32 v75, v79
    v_mul_f32 v76, v72, v76
    v_mfma_f32_16x16x32_bf16 v[44:47], v[136:139], a[64:67], 0
    v_mul_f32 v72, v72, v123
    v_mul_f32 v77, v73, v77
    v_mul_f32_e64 v73, v73, v123
    v_mfma_f32_16x16x32_bf16 v[52:55], v[140:143], a[64:67], 0
    s_xor_b32 s58, s71, 163840
    buffer_load_dwordx4 a[76:79], v15, s[48:51], s58 offen offset:0 sc1
    v_exp_f32 v72, v72
    s_waitcnt vmcnt(10)
    v_mfma_f32_16x16x32_bf16 v[16:19], v[144:147], a[128:131], v[16:19]
    v_exp_f32_e64 v73, v73
    v_fma_f32 v72, v72, v127, v127
    v_mfma_f32_16x16x32_bf16 v[32:35], v[148:151], a[128:131], v[32:35]
    v_fma_f32 v73, v73, v127, v127
    v_rcp_f32_e64 v72, v72
    v_mfma_f32_16x16x32_bf16 v[40:43], v[152:155], a[128:131], v[40:43]
    v_rcp_f32_e64 v73, v73
    v_mul_f32_e64 v72, v72, v76
    v_mfma_f32_16x16x32_bf16 v[48:51], v[156:159], a[128:131], v[48:51]
    buffer_load_dwordx4 a[140:143], v15, s[48:51], s58 offen offset:256 sc1
    v_mul_f32 v73, v73, v77
    v_cvt_pk_bf16_f32 v112, v72, v73
    s_waitcnt vmcnt(10)
    v_mfma_f32_16x16x32_bf16 v[20:23], v[144:147], a[4:7], v[20:23]
    v_cvt_pk_bf16_f32 v114, v72, v73
    v_mul_f32 v78, v74, v78
    v_mul_f32 v74, v74, v123
    v_mfma_f32_16x16x32_bf16 v[36:39], v[148:151], a[4:7], v[36:39]
    v_mul_f32 v79, v75, v79
    v_mul_f32 v75, v75, v123
    v_mfma_f32_16x16x32_bf16 v[44:47], v[152:155], a[4:7], v[44:47]
    v_exp_f32_e64 v74, v74
    v_mfma_f32_16x16x32_bf16 v[52:55], v[156:159], a[4:7], v[52:55]
    s_xor_b32 s58, s71, 196608
    buffer_load_dwordx4 a[16:19], v15, s[48:51], s58 offen offset:0 sc1
    v_exp_f32 v75, v75
    s_waitcnt vmcnt(9)
    v_mfma_f32_16x16x32_bf16 v[16:19], v[160:163], a[68:71], v[16:19]
    s_atomic_add s62, s[22:23], s27 offset:49152
    v_fma_f32 v74, v74, v127, v127
    v_fma_f32 v75, v75, v127, v127
    v_mfma_f32_16x16x32_bf16 v[32:35], v[164:167], a[68:71], v[32:35]
    v_rcp_f32_e64 v74, v74
    v_mfma_f32_16x16x32_bf16 v[40:43], v[168:171], a[68:71], v[40:43]
    v_rcp_f32_e64 v75, v75
    v_mul_f32_e64 v74, v74, v78
    v_mfma_f32_16x16x32_bf16 v[48:51], v[172:175], a[68:71], v[48:51]
    buffer_load_dwordx4 a[80:83], v15, s[48:51], s58 offen offset:256 sc1
    v_mul_f32 v75, v75, v79
    v_cvt_pk_bf16_f32 v113, v74, v75
    s_waitcnt vmcnt(9)
    v_mfma_f32_16x16x32_bf16 v[20:23], v[160:163], a[132:135], v[20:23]
    v_cvt_pk_bf16_f32 v115, v74, v75
    v_permlane16_swap_b32 v112, v114
    v_mfma_f32_16x16x32_bf16 v[36:39], v[164:167], a[132:135], v[36:39]
    v_permlane16_swap_b32 v113, v115
    v_mfma_f32_16x16x32_bf16 v[44:47], v[168:171], a[132:135], v[44:47]
    buffer_store_dwordx4 v[112:115], v11, s[48:51], s6 offen offset:1024 sc1
    v_mfma_f32_16x16x32_bf16 v[52:55], v[172:175], a[132:135], v[52:55]
    s_xor_b32 s58, s71, 229376
    buffer_load_dwordx4 a[144:147], v15, s[48:51], s58 offen offset:0 sc1
    s_waitcnt vmcnt(10)
    v_mfma_f32_16x16x32_bf16 v[16:19], v[176:179], a[8:11], v[16:19]
    v_mfma_f32_16x16x32_bf16 v[32:35], v[180:183], a[8:11], v[32:35]
    s_nop 0
    v_mfma_f32_16x16x32_bf16 v[40:43], v[184:187], a[8:11], v[40:43]
    v_mfma_f32_16x16x32_bf16 v[48:51], v[188:191], a[8:11], v[48:51]
    s_nop 0
    buffer_load_dwordx4 a[20:23], v15, s[48:51], s58 offen offset:256 sc1
    s_waitcnt vmcnt(10)
    v_mfma_f32_16x16x32_bf16 v[20:23], v[176:179], a[72:75], v[20:23]
    v_mfma_f32_16x16x32_bf16 v[36:39], v[180:183], a[72:75], v[36:39]
    v_mfma_f32_16x16x32_bf16 v[44:47], v[184:187], a[72:75], v[44:47]
    v_mfma_f32_16x16x32_bf16 v[52:55], v[188:191], a[72:75], v[52:55]
    s_mov_b32 s58, 262144
    buffer_load_dwordx4 a[84:87], v15, s[48:51], s58 offen offset:0 sc1
    s_waitcnt vmcnt(10)
    v_mfma_f32_16x16x32_bf16 v[16:19], v[192:195], a[136:139], v[16:19]
    s_nop 0
    v_mfma_f32_16x16x32_bf16 v[32:35], v[196:199], a[136:139], v[32:35]
    v_mfma_f32_16x16x32_bf16 v[40:43], v[200:203], a[136:139], v[40:43]
    v_mfma_f32_16x16x32_bf16 v[48:51], v[204:207], a[136:139], v[48:51]
    buffer_load_dwordx4 a[148:151], v15, s[48:51], s58 offen offset:256 sc1
    s_waitcnt vmcnt(9)
    v_mfma_f32_16x16x32_bf16 v[20:23], v[192:195], a[12:15], v[20:23]
    s_atomic_add s62, s[22:23], s19 offset:65536
    v_mfma_f32_16x16x32_bf16 v[36:39], v[196:199], a[12:15], v[36:39]
    s_nop 0
    v_mfma_f32_16x16x32_bf16 v[44:47], v[200:203], a[12:15], v[44:47]
    v_mfma_f32_16x16x32_bf16 v[52:55], v[204:207], a[12:15], v[52:55]
    s_mov_b32 s58, 294912
    buffer_load_dwordx4 a[24:27], v15, s[48:51], s58 offen offset:0 sc1
    s_waitcnt vmcnt(9)
    v_mfma_f32_16x16x32_bf16 v[16:19], v[208:211], a[76:79], v[16:19]
    s_mov_b32 s1, 0
    s_atomic_add s1, s[22:23], s61 offset:49152 glc
    v_mfma_f32_16x16x32_bf16 v[32:35], v[212:215], a[76:79], v[32:35]
    v_mfma_f32_16x16x32_bf16 v[40:43], v[216:219], a[76:79], v[40:43]
    v_mfma_f32_16x16x32_bf16 v[48:51], v[220:223], a[76:79], v[48:51]
    s_nop 0
    buffer_load_dwordx4 a[88:91], v15, s[48:51], s58 offen offset:256 sc1
    s_waitcnt vmcnt(9)
    v_mfma_f32_16x16x32_bf16 v[20:23], v[208:211], a[140:143], v[20:23]
    v_mfma_f32_16x16x32_bf16 v[36:39], v[212:215], a[140:143], v[36:39]
    v_mfma_f32_16x16x32_bf16 v[44:47], v[216:219], a[140:143], v[44:47]
    v_mfma_f32_16x16x32_bf16 v[52:55], v[220:223], a[140:143], v[52:55]
    s_mov_b32 s58, 327680
    buffer_load_dwordx4 a[152:155], v12, s[48:51], s58 offen offset:0 sc1
    s_waitcnt vmcnt(9)
    v_mfma_f32_16x16x32_bf16 v[16:19], v[224:227], a[16:19], v[16:19]
    s_nop 0
    v_mfma_f32_16x16x32_bf16 v[32:35], v[228:231], a[16:19], v[32:35]
    v_mfma_f32_16x16x32_bf16 v[40:43], v[232:235], a[16:19], v[40:43]
    v_mfma_f32_16x16x32_bf16 v[48:51], v[236:239], a[16:19], v[48:51]
    buffer_load_dwordx4 a[28:31], v12, s[48:51], s58 offen offset:256 sc1
    s_waitcnt vmcnt(9)
    v_mfma_f32_16x16x32_bf16 v[20:23], v[224:227], a[80:83], v[20:23]
    s_nop 0
    v_mfma_f32_16x16x32_bf16 v[36:39], v[228:231], a[80:83], v[36:39]
    v_mfma_f32_16x16x32_bf16 v[44:47], v[232:235], a[80:83], v[44:47]
    s_nop 0
    v_mfma_f32_16x16x32_bf16 v[52:55], v[236:239], a[80:83], v[52:55]
    s_waitcnt vmcnt(7)
    v_mfma_f32_16x16x32_bf16 v[16:19], v[240:243], a[144:147], v[16:19]
    v_mfma_f32_16x16x32_bf16 v[32:35], v[244:247], a[144:147], v[32:35]
    v_mfma_f32_16x16x32_bf16 v[40:43], v[248:251], a[144:147], v[40:43]
    v_mfma_f32_16x16x32_bf16 v[48:51], v[252:255], a[144:147], v[48:51]
    s_waitcnt vmcnt(6)
    v_mfma_f32_16x16x32_bf16 v[20:23], v[240:243], a[20:23], v[20:23]
    s_nop 0
    v_mfma_f32_16x16x32_bf16 v[36:39], v[244:247], a[20:23], v[36:39]
    v_mfma_f32_16x16x32_bf16 v[44:47], v[248:251], a[20:23], v[44:47]
    v_and_b32 v13, 32, v10
    v_mfma_f32_16x16x32_bf16 v[52:55], v[252:255], a[20:23], v[52:55]
    v_xor_b32 v13, v13, v1
    s_waitcnt vmcnt(5)
    v_mfma_f32_16x16x32_bf16 v[16:19], a[192:195], a[84:87], v[16:19]
    s_cmp_eq_u32 s1, 8
    s_cbranch_scc0 L_slow_31
L_ok_30:
    s_xor_b32 s58, s71, 0
    buffer_load_dwordx4 a[92:95], v15, s[48:51], s58 offen offset:1024 sc1
    s_mul_i32 s57, s52, 2112
    v_mfma_f32_16x16x32_bf16 v[32:35], a[196:199], a[84:87], v[32:35]
    v_xor_b32_e64 v13, s57, v13
    v_mfma_f32_16x16x32_bf16 v[40:43], a[200:203], a[84:87], v[40:43]
    s_atomic_add s62, s[22:23], s19 offset:81920
    v_add_u32_e64 v120, s66, v13
    v_mfma_f32_16x16x32_bf16 v[48:51], a[204:207], a[84:87], v[48:51]
    v_xor_b32 v121, 2112, v120
    s_waitcnt vmcnt(5)
    v_mfma_f32_16x16x32_bf16 v[20:23], a[192:195], a[148:151], v[20:23]
    s_mov_b32 s1, 0
    s_atomic_add s1, s[22:23], s61 offset:65536 glc
    buffer_load_dwordx4 a[156:159], v15, s[48:51], s58 offen offset:1280 sc1
    v_xor_b32 v122, 4224, v120
    v_mfma_f32_16x16x32_bf16 v[36:39], a[196:199], a[148:151], v[36:39]
    v_xor_b32 v123, 6336, v120
    v_mfma_f32_16x16x32_bf16 v[44:47], a[200:203], a[148:151], v[44:47]
    v_lshrrev_b32_e64 v125, 3, v10
    v_mfma_f32_16x16x32_bf16 v[52:55], a[204:207], a[148:151], v[52:55]
    s_lshl_b32 s57, s52, 3
    s_waitcnt vmcnt(5)
    v_mfma_f32_16x16x32_bf16 v[16:19], a[208:211], a[24:27], v[16:19]
    s_xor_b32 s58, s71, 65536
    buffer_load_dwordx4 a[32:35], v15, s[48:51], s58 offen offset:1024 sc1
    v_add_u32_e64 v125, s57, v125
    v_mfma_f32_16x16x32_bf16 v[32:35], a[212:215], a[24:27], v[32:35]
    v_and_b32_e64 v13, 7, v10
    v_mfma_f32_16x16x32_bf16 v[40:43], a[216:219], a[24:27], v[40:43]
    v_lshlrev_b32 v124, 1, v13
    v_mfma_f32_16x16x32_bf16 v[48:51], a[220:223], a[24:27], v[48:51]
L_pad6:
    s_cbranch_execz L_pad7
    v_xor_b32 v124, v124, v125
    s_waitcnt vmcnt(5)
    v_mfma_f32_16x16x32_bf16 v[20:23], a[208:211], a[88:91], v[20:23]
    buffer_load_dwordx4 a[96:99], v15, s[48:51], s58 offen offset:1280 sc1
    v_and_b32_e64 v124, 15, v124
    v_mfma_f32_16x16x32_bf16 v[36:39], a[212:215], a[88:91], v[36:39]
    v_lshlrev_b32_e64 v124, 4, v124
    v_mfma_f32_16x16x32_bf16 v[44:47], a[216:219], a[88:91], v[44:47]
    v_lshlrev_b32_e64 v125, 10, v125
    v_mfma_f32_16x16x32_bf16 v[52:55], a[220:223], a[88:91], v[52:55]
    v_lshl_add_u32 v125, v13, 4, v125
    s_waitcnt vmcnt(5)
    v_mfma_f32_16x16x32_bf16 v[16:19], a[224:227], a[152:155], v[16:19]
    s_barrier
    s_xor_b32 s58, s71, 131072
    buffer_load_dwordx4 a[160:163], v15, s[48:51], s58 offen offset:1024 sc1
    v_and_b32 v112, 6, v13
    v_mfma_f32_16x16x32_bf16 v[32:35], a[228:231], a[152:155], v[32:35]
    v_add_u32 v13, v13, v112
    v_mfma_f32_16x16x32_bf16 v[40:43], a[232:235], a[152:155], v[40:43]
    v_lshl_add_u32 v124, v13, 9, v124
    v_mfma_f32_16x16x32_bf16 v[48:51], a[236:239], a[152:155], v[48:51]
    s_lshr_b32 s57, s52, 1
    s_waitcnt vmcnt(5)
    v_mfma_f32_16x16x32_bf16 v[20:23], a[224:227], a[28:31], v[20:23]
    buffer_load_dwordx4 a[36:39], v15, s[48:51], s58 offen offset:1280 sc1
    s_lshl_b32 s57, s57, 10
    v_mfma_f32_16x16x32_bf16 v[36:39], a[228:231], a[28:31], v[36:39]
    s_nop 0
    v_add_u32_e64 v124, s57, v124
    v_mfma_f32_16x16x32_bf16 v[44:47], a[232:235], a[28:31], v[44:47]
    s_lshl_b32 s4, s53, 16
    v_mfma_f32_16x16x32_bf16 v[52:55], a[236:239], a[28:31], v[52:55]
    s_lshl_b32 s57, s54, 7
    s_waitcnt vmcnt(5)
    v_mfma_f32_16x16x32_bf16 v[24:27], v[128:131], a[92:95], v[24:27]
    s_xor_b32 s58, s71, 196608
    buffer_load_dwordx4 a[100:103], v15, s[48:51], s58 offen offset:1024 sc1
    s_add_u32 s4, s4, s57
    v_mfma_f32_16x16x32_bf16 v[56:59], v[132:135], a[92:95], 0
    s_add_u32 s5, s4, 32768
    v_mfma_f32_16x16x32_bf16 v[64:67], v[136:139], a[92:95], 0
    v_mfma_f32_16x16x32_bf16 v[72:75], v[140:143], a[92:95], 0
    s_nop 0
    ds_write_b128 v120, v[16:19] offset:0
    s_waitcnt vmcnt(5)
    v_mfma_f32_16x16x32_bf16 v[28:31], v[128:131], a[156:159], v[28:31]
    s_cmp_eq_u32 s1, 8
    s_cbranch_scc0 L_slow_34
L_ok_33:
    buffer_load_dwordx4 a[164:167], v15, s[48:51], s58 offen offset:1280 sc1
    v_mfma_f32_16x16x32_bf16 v[60:63], v[132:135], a[156:159], 0
    v_mfma_f32_16x16x32_bf16 v[68:71], v[136:139], a[156:159], 0
    v_mfma_f32_16x16x32_bf16 v[76:79], v[140:143], a[156:159], 0
    s_nop 0
    ds_write_b128 v121, v[32:35] offset:0
    s_waitcnt vmcnt(5)
    v_mfma_f32_16x16x32_bf16 v[24:27], v[160:163], a[32:35], v[24:27]
    s_xor_b32 s58, s71, 32768
    buffer_load_dwordx4 a[40:43], v15, s[48:51], s58 offen offset:1024 sc1
    v_mfma_f32_16x16x32_bf16 v[56:59], v[164:167], a[32:35], v[56:59]
    s_nop 0
    v_mfma_f32_16x16x32_bf16 v[64:67], v[168:171], a[32:35], v[64:67]
    s_mov_b32 s1, 0
    s_atomic_add s1, s[22:23], s61 offset:81920 glc
    v_mfma_f32_16x16x32_bf16 v[72:75], v[172:175], a[32:35], v[72:75]
    s_nop 0
    ds_write_b128 v122, v[40:43] offset:0
    s_waitcnt vmcnt(5)
    v_mfma_f32_16x16x32_bf16 v[28:31], v[160:163], a[96:99], v[28:31]
    buffer_load_dwordx4 a[104:107], v15, s[48:51], s58 offen offset:1280 sc1
    v_mfma_f32_16x16x32_bf16 v[60:63], v[164:167], a[96:99], v[60:63]
    v_mfma_f32_16x16x32_bf16 v[68:71], v[168:171], a[96:99], v[68:71]
    v_mfma_f32_16x16x32_bf16 v[76:79], v[172:175], a[96:99], v[76:79]
    s_nop 0
    ds_write_b128 v123, v[48:51] offset:0
    s_waitcnt vmcnt(5)
    v_mfma_f32_16x16x32_bf16 v[24:27], v[192:195], a[160:163], v[24:27]
    s_xor_b32 s58, s71, 98304
    buffer_load_dwordx4 a[168:171], v15, s[48:51], s58 offen offset:1024 sc1
    v_mfma_f32_16x16x32_bf16 v[56:59], v[196:199], a[160:163], v[56:59]
    v_mfma_f32_16x16x32_bf16 v[64:67], v[200:203], a[160:163], v[64:67]
    v_mfma_f32_16x16x32_bf16 v[72:75], v[204:207], a[160:163], v[72:75]
    ds_write_b128 v120, v[20:23] offset:1024
    s_waitcnt vmcnt(5)
    v_mfma_f32_16x16x32_bf16 v[28:31], v[192:195], a[36:39], v[28:31]
    s_nop 0
    buffer_load_dwordx4 a[44:47], v15, s[48:51], s58 offen offset:1280 sc1
    v_mfma_f32_16x16x32_bf16 v[60:63], v[196:199], a[36:39], v[60:63]
    v_mfma_f32_16x16x32_bf16 v[68:71], v[200:203], a[36:39], v[68:71]
    v_mfma_f32_16x16x32_bf16 v[76:79], v[204:207], a[36:39], v[76:79]
    s_nop 0
    ds_write_b128 v121, v[36:39] offset:1024
    s_waitcnt vmcnt(5)
    v_mfma_f32_16x16x32_bf16 v[24:27], v[224:227], a[100:103], v[24:27]
    s_xor_b32 s58, s71, 163840
    buffer_load_dwordx4 a[108:111], v15, s[48:51], s58 offen offset:1024 sc1
    v_mfma_f32_16x16x32_bf16 v[56:59], v[228:231], a[100:103], v[56:59]
    s_nop 0
    v_mfma_f32_16x16x32_bf16 v[64:67], v[232:235], a[100:103], v[64:67]
    s_nop 0
    v_mfma_f32_16x16x32_bf16 v[72:75], v[236:239], a[100:103], v[72:75]
    ds_write_b128 v122, v[44:47] offset:1024
    s_waitcnt vmcnt(5)
    v_mfma_f32_16x16x32_bf16 v[28:31], v[224:227], a[164:167], v[28:31]
    s_nop 0
    buffer_load_dwordx4 a[172:175], v15, s[48:51], s58 offen offset:1280 sc1
    v_mfma_f32_16x16x32_bf16 v[60:63], v[228:231], a[164:167], v[60:63]
    v_mfma_f32_16x16x32_bf16 v[68:71], v[232:235], a[164:167], v[68:71]
    v_mfma_f32_16x16x32_bf16 v[76:79], v[236:239], a[164:167], v[76:79]
    s_nop 0
    ds_write_b128 v123, v[52:55] offset:1024
    s_waitcnt vmcnt(5)
    v_mfma_f32_16x16x32_bf16 v[24:27], v[144:147], a[40:43], v[24:27]
    s_xor_b32 s58, s71, 229376
    buffer_load_dwordx4 a[48:51], v15, s[48:51], s58 offen offset:1024 sc1
    v_mfma_f32_16x16x32_bf16 v[56:59], v[148:151], a[40:43], v[56:59]
    s_nop 0
    v_mfma_f32_16x16x32_bf16 v[64:67], v[152:155], a[40:43], v[64:67]
    s_cmp_eq_u32 s1, 8
    s_cbranch_scc0 L_slow_37
L_ok_36:
    v_mfma_f32_16x16x32_bf16 v[72:75], v[156:159], a[40:43], v[72:75]
    s_waitcnt vmcnt(5)
    v_mfma_f32_16x16x32_bf16 v[28:31], v[144:147], a[104:107], v[28:31]
    buffer_load_dwordx4 a[112:115], v15, s[48:51], s58 offen offset:1280 sc1
    v_mfma_f32_16x16x32_bf16 v[60:63], v[148:151], a[104:107], v[60:63]
    v_mfma_f32_16x16x32_bf16 v[68:71], v[152:155], a[104:107], v[68:71]
    s_waitcnt lgkmcnt(0)
    s_barrier
    ds_read_b128 v[80:83], v124 offset:0
    v_mfma_f32_16x16x32_bf16 v[76:79], v[156:159], a[104:107], v[76:79]
    s_nop 0
    ds_read_b128 v[84:87], v124 offset:256
    s_waitcnt vmcnt(5)
    v_mfma_f32_16x16x32_bf16 v[24:27], v[176:179], a[168:171], v[24:27]
    s_mov_b32 s58, 262144
    buffer_load_dwordx4 a[176:179], v15, s[48:51], s58 offen offset:1024 sc1
    ds_read_b128 v[88:91], v124 offset:8192
    v_mfma_f32_16x16x32_bf16 v[56:59], v[180:183], a[168:171], v[56:59]
    ds_read_b128 v[92:95], v124 offset:8448
    v_mfma_f32_16x16x32_bf16 v[64:67], v[184:187], a[168:171], v[64:67]
    ds_read_b128 v[96:99], v124 offset:16384
    v_mfma_f32_16x16x32_bf16 v[72:75], v[188:191], a[168:171], v[72:75]
    s_nop 0
    ds_read_b128 v[100:103], v124 offset:16640
    s_waitcnt vmcnt(5)
    v_mfma_f32_16x16x32_bf16 v[28:31], v[176:179], a[44:47], v[28:31]
    buffer_load_dwordx4 a[52:55], v15, s[48:51], s58 offen offset:1280 sc1
    ds_read_b128 v[104:107], v124 offset:24576
    v_mfma_f32_16x16x32_bf16 v[60:63], v[180:183], a[44:47], v[60:63]
    ds_read_b128 v[108:111], v124 offset:24832
    v_mfma_f32_16x16x32_bf16 v[68:71], v[184:187], a[44:47], v[68:71]
    s_nop 0
    v_mfma_f32_16x16x32_bf16 v[76:79], v[188:191], a[44:47], v[76:79]
    s_waitcnt vmcnt(5)
    v_mfma_f32_16x16x32_bf16 v[24:27], v[208:211], a[108:111], v[24:27]
    s_mov_b32 s58, 294912
    buffer_load_dwordx4 a[116:119], v15, s[48:51], s58 offen offset:1024 sc1
    v_mfma_f32_16x16x32_bf16 v[56:59], v[212:215], a[108:111], v[56:59]
    v_mfma_f32_16x16x32_bf16 v[64:67], v[216:219], a[108:111], v[64:67]
    s_waitcnt lgkmcnt(5)
    v_add_f32 v80, v80, v88
    v_add_f32 v81, v81, v89
    v_mfma_f32_16x16x32_bf16 v[72:75], v[220:223], a[108:111], v[72:75]
    v_add_f32 v82, v82, v90
    v_add_f32 v83, v83, v91
    s_waitcnt vmcnt(5)
    v_mfma_f32_16x16x32_bf16 v[28:31], v[208:211], a[172:175], v[28:31]
    buffer_load_dwordx4 a[180:183], v15, s[48:51], s58 offen offset:1280 sc1
    s_waitcnt lgkmcnt(4)
    v_add_f32 v84, v84, v92
    v_add_f32 v85, v85, v93
    v_mfma_f32_16x16x32_bf16 v[60:63], v[212:215], a[172:175], v[60:63]
    v_add_f32 v86, v86, v94
    v_add_f32 v87, v87, v95
    v_mfma_f32_16x16x32_bf16 v[68:71], v[216:219], a[172:175], v[68:71]
    s_waitcnt lgkmcnt(1)
    v_add_f32 v96, v96, v104
    v_add_f32 v97, v97, v105
    v_mfma_f32_16x16x32_bf16 v[76:79], v[220:223], a[172:175], v[76:79]
    v_add_f32 v98, v98, v106
    v_add_f32_e64 v99, v99, v107
    s_waitcnt vmcnt(5)
    v_mfma_f32_16x16x32_bf16 v[24:27], v[240:243], a[48:51], v[24:27]
    s_mov_b32 s58, 327680
    buffer_load_dwordx4 a[56:59], v12, s[48:51], s58 offen offset:1024 sc1
    s_waitcnt lgkmcnt(0)
    v_add_f32 v100, v100, v108
    v_add_f32 v101, v101, v109
    v_mfma_f32_16x16x32_bf16 v[56:59], v[244:247], a[48:51], v[56:59]
    v_add_f32 v102, v102, v110
    v_add_f32 v103, v103, v111
    v_mfma_f32_16x16x32_bf16 v[64:67], v[248:251], a[48:51], v[64:67]
    v_add_f32 v80, v80, v96
    v_add_f32 v81, v81, v97
    v_mfma_f32_16x16x32_bf16 v[72:75], v[252:255], a[48:51], v[72:75]
    v_add_f32 v82, v82, v98
    v_add_f32 v83, v83, v99
    s_waitcnt vmcnt(5)
    v_mfma_f32_16x16x32_bf16 v[28:31], v[240:243], a[112:115], v[28:31]
    buffer_load_dwordx4 a[120:123], v12, s[48:51], s58 offen offset:1280 sc1
    v_add_f32 v84, v84, v100
    v_add_f32 v85, v85, v101
    v_mfma_f32_16x16x32_bf16 v[60:63], v[244:247], a[112:115], v[60:63]
    v_add_f32 v86, v86, v102
    v_add_f32 v87, v87, v103
    v_mfma_f32_16x16x32_bf16 v[68:71], v[248:251], a[112:115], v[68:71]
    v_cvt_pk_bf16_f32 v112, v80, v81
    v_cvt_pk_bf16_f32 v113, v82, v83
    v_mfma_f32_16x16x32_bf16 v[76:79], v[252:255], a[112:115], v[76:79]
    v_cvt_pk_bf16_f32 v114, v84, v85
    v_cvt_pk_bf16_f32 v115, v86, v87
    s_waitcnt vmcnt(5)
    v_mfma_f32_16x16x32_bf16 v[24:27], a[192:195], a[176:179], v[24:27]
    s_nop 0
    v_mfma_f32_16x16x32_bf16 v[56:59], a[196:199], a[176:179], v[56:59]
    v_mfma_f32_16x16x32_bf16 v[64:67], a[200:203], a[176:179], v[64:67]
    s_nop 0
    v_mfma_f32_16x16x32_bf16 v[72:75], a[204:207], a[176:179], v[72:75]
    s_waitcnt vmcnt(3)
    v_mfma_f32_16x16x32_bf16 v[24:27], a[208:211], a[116:119], v[24:27]
    buffer_store_dwordx4 v[112:115], v125, s[44:47], s4 offen sc1
    v_mfma_f32_16x16x32_bf16 v[56:59], a[212:215], a[116:119], v[56:59]
    v_mfma_f32_16x16x32_bf16 v[64:67], a[216:219], a[116:119], v[64:67]
    s_nop 0
    v_mfma_f32_16x16x32_bf16 v[72:75], a[220:223], a[116:119], v[72:75]
    s_waitcnt vmcnt(2)
    v_mfma_f32_16x16x32_bf16 v[24:27], a[224:227], a[56:59], v[24:27]
    v_mfma_f32_16x16x32_bf16 v[56:59], a[228:231], a[56:59], v[56:59]
    v_mfma_f32_16x16x32_bf16 v[64:67], a[232:235], a[56:59], v[64:67]
    v_mfma_f32_16x16x32_bf16 v[72:75], a[236:239], a[56:59], v[72:75]
    v_mfma_f32_16x16x32_bf16 v[28:31], a[192:195], a[52:55], v[28:31]
    v_mfma_f32_16x16x32_bf16 v[60:63], a[196:199], a[52:55], v[60:63]
    s_nop 0
    v_mfma_f32_16x16x32_bf16 v[68:71], a[200:203], a[52:55], v[68:71]
    s_nop 1
    ds_write_b128 v120, v[24:27] offset:32768
    v_mfma_f32_16x16x32_bf16 v[76:79], a[204:207], a[52:55], v[76:79]
    v_mfma_f32_16x16x32_bf16 v[28:31], a[208:211], a[180:183], v[28:31]
    v_mfma_f32_16x16x32_bf16 v[60:63], a[212:215], a[180:183], v[60:63]
    ds_write_b128 v121, v[56:59] offset:32768
    v_mfma_f32_16x16x32_bf16 v[68:71], a[216:219], a[180:183], v[68:71]
    s_nop 0
    v_mfma_f32_16x16x32_bf16 v[76:79], a[220:223], a[180:183], v[76:79]
    s_waitcnt vmcnt(1)
    v_mfma_f32_16x16x32_bf16 v[28:31], a[224:227], a[120:123], v[28:31]
    ds_write_b128 v122, v[64:67] offset:32768
    v_mfma_f32_16x16x32_bf16 v[60:63], a[228:231], a[120:123], v[60:63]
    v_mfma_f32_16x16x32_bf16 v[68:71], a[232:235], a[120:123], v[68:71]
    v_mfma_f32_16x16x32_bf16 v[76:79], a[236:239], a[120:123], v[76:79]
    ds_write_b128 v123, v[72:75] offset:32768
    s_nop 2
    ds_write_b128 v120, v[28:31] offset:33792
    s_nop 0
    ds_write_b128 v121, v[60:63] offset:33792
    ds_write_b128 v122, v[68:71] offset:33792
    ds_write_b128 v123, v[76:79] offset:33792
    s_waitcnt lgkmcnt(0)
    s_barrier
    ds_read_b128 v[80:83], v124 offset:32768
    ds_read_b128 v[84:87], v124 offset:33024
    ds_read_b128 v[88:91], v124 offset:40960
    ds_read_b128 v[92:95], v124 offset:41216
    ds_read_b128 v[96:99], v124 offset:49152
    ds_read_b128 v[100:103], v124 offset:49408
    ds_read_b128 v[104:107], v124 offset:57344
    ds_read_b128 v[108:111], v124 offset:57600
    s_waitcnt lgkmcnt(5)
    v_pk_add_f32 v[80:81], v[80:81], v[88:89]
    v_pk_add_f32 v[82:83], v[82:83], v[90:91]
    s_waitcnt lgkmcnt(4)
    v_pk_add_f32 v[84:85], v[84:85], v[92:93]
    v_pk_add_f32 v[86:87], v[86:87], v[94:95]
    s_waitcnt lgkmcnt(1)
    v_pk_add_f32 v[96:97], v[96:97], v[104:105]
    v_pk_add_f32 v[98:99], v[98:99], v[106:107]
    s_waitcnt lgkmcnt(0)
    v_pk_add_f32 v[100:101], v[100:101], v[108:109]
    v_pk_add_f32 v[102:103], v[102:103], v[110:111]
    v_pk_add_f32 v[80:81], v[80:81], v[96:97]
    v_pk_add_f32 v[82:83], v[82:83], v[98:99]
    v_pk_add_f32 v[84:85], v[84:85], v[100:101]
    v_pk_add_f32 v[86:87], v[86:87], v[102:103]
    v_cvt_pk_bf16_f32 v116, v80, v81
    v_cvt_pk_bf16_f32 v117, v82, v83
    v_cvt_pk_bf16_f32 v118, v84, v85
    v_cvt_pk_bf16_f32 v119, v86, v87
    buffer_store_dwordx4 v[116:119], v125, s[44:47], s5 offen
    s_endpgm
L_again_2:
    global_load_dword v186, v13, s[20:21] sc1
    s_sub_u32 s3, s3, 1
    s_cbranch_scc1 L_end
    s_waitcnt vmcnt(0)
    v_readfirstlane_b32 s56, v186
    s_nop 0
    s_and_b32 s57, s56, 0xf0
    s_cbranch_scc0 L_again_2
    s_branch L_ok_1
L_again_8:
    s_mov_b32 s1, 0
    s_atomic_add s1, s[22:23], s9 offset:98304 glc
    s_sub_u32 s3, s3, 1
    s_cbranch_scc1 L_end
    s_waitcnt lgkmcnt(0)
    s_cmp_eq_u32 s1, 4
    s_cbranch_scc0 L_again_8
    s_branch L_ok_7
L_slow_10:
L_again_11:
    s_mov_b32 s1, 0
    s_atomic_add s1, s[22:23], s6 offset:114688 glc
    s_sub_u32 s3, s3, 1
    s_cbranch_scc1 L_end
    s_waitcnt lgkmcnt(0)
    s_cmp_eq_u32 s1, 8
    s_cbranch_scc0 L_again_11
    s_branch L_ok_9
L_ok_13_s:
    v_max_u32_e64 v228, v192, v193
    v_max3_u32 v228, v228, v194, v195
    v_max3_u32 v228, v228, v196, v197
    v_max3_u32 v228, v228, v198, v199
    v_max3_u32 v228, v228, v200, v201
    v_max3_u32 v228, v228, v202, v203
    v_max3_u32 v228, v228, v204, v205
    v_max3_u32 v228, v228, v206, v207
    v_max3_u32 v228, v228, v208, v209
    v_max3_u32 v228, v228, v210, v211
    v_max3_u32 v228, v228, v212, v213
    v_max3_u32 v228, v228, v214, v215
    v_max3_u32 v228, v228, v216, v217
    v_max3_u32 v228, v228, v218, v219
    v_max3_u32 v228, v228, v220, v221
    v_max3_u32 v228, v228, v222, v223
    v_max3_u32 v228, v228, v224, v225
    v_max3_u32 v228, v228, v226, v227
    v_cmp_eq_u32 vcc, -1, v228
    s_nop 0
    s_nop 0
    s_cbranch_vccz L_ok_13
    buffer_load_dwordx4 v[224:227], v185, s[48:51], s17 offen sc1
    buffer_load_dwordx4 v[192:195], v1, s[48:51], s17 offen offset:0 sc1
    buffer_load_dwordx4 v[196:199], v1, s[48:51], s17 offen offset:1152 sc1
    buffer_load_dwordx4 v[200:203], v1, s[48:51], s17 offen offset:2304 sc1
    buffer_load_dwordx4 v[204:207], v1, s[48:51], s17 offen offset:3456 sc1
    s_add_u32 s58, s17, 16384
    buffer_load_dwordx4 v[208:211], v1, s[48:51], s58 offen offset:0 sc1
    buffer_load_dwordx4 v[212:215], v1, s[48:51], s58 offen offset:1152 sc1
    buffer_load_dwordx4 v[216:219], v1, s[48:51], s58 offen offset:2304 sc1
    buffer_load_dwordx4 v[220:223], v1, s[48:51], s58 offen offset:3456 sc1
    s_sub_u32 s3, s3, 1
    s_cbranch_scc1 L_end
    s_waitcnt vmcnt(0)
    s_branch L_again_12
L_again_15:
    s_mov_b32 s1, 0
    s_atomic_add s1, s[22:23], s9 offset:98304 glc
    s_sub_u32 s3, s3, 1
    s_cbranch_scc1 L_end
    s_waitcnt lgkmcnt(0)
    s_cmp_eq_u32 s1, 4
    s_cbranch_scc0 L_again_15
    s_branch L_ok_14
L_ok_17_s:
    v_max_u32 v212, v192, v193
    v_max3_u32 v212, v212, v194, v195
    v_max3_u32 v212, v212, v196, v197
    v_max3_u32 v212, v212, v198, v199
    v_max3_u32 v212, v212, v200, v201
    v_max3_u32 v212, v212, v202, v203
    v_max3_u32 v212, v212, v204, v205
    v_max3_u32 v212, v212, v206, v207
    v_max3_u32 v212, v212, v208, v209
    v_max3_u32 v212, v212, v210, v211
    v_cmp_eq_u32 vcc, -1, v212
    s_nop 0
    s_nop 0
    s_cbranch_vccz L_ok_17
    buffer_load_dwordx4 v[208:211], v11, s[48:51], s18 offen sc1
    buffer_load_dwordx4 v[192:195], v1, s[48:51], s18 offen offset:0 sc1
    buffer_load_dwordx4 v[196:199], v1, s[48:51], s18 offen offset:1152 sc1
    buffer_load_dwordx4 v[200:203], v1, s[48:51], s18 offen offset:2304 sc1
    buffer_load_dwordx4 v[204:207], v1, s[48:51], s18 offen offset:3456 sc1
    s_sub_u32 s3, s3, 1
    s_cbranch_scc1 L_end
    s_waitcnt vmcnt(0)
    s_branch L_again_16
L_slow_19:
    s_waitcnt lgkmcnt(0)
    s_cmp_eq_u32 s1, 7
    s_cbranch_scc1 L_ok_18
L_again_20:
    s_mov_b32 s1, 0
    s_atomic_add s1, s[22:23], s61 offset:0 glc
    s_sub_u32 s3, s3, 1
    s_cbranch_scc1 L_end
    s_waitcnt lgkmcnt(0)
    s_cmp_eq_u32 s1, 8
    s_cbranch_scc0 L_again_20
    s_branch L_ok_18
L_slow_23:
    s_waitcnt lgkmcnt(0)
    s_cmp_eq_u32 s1, 16
    s_cbranch_scc1 L_ok_22
L_again_24:
    s_mov_b32 s1, 0
    s_atomic_add s1, s[22:23], s26 offset:16384 glc
    s_sub_u32 s3, s3, 1
    s_cbranch_scc1 L_end
    s_waitcnt lgkmcnt(0)
    s_cmp_eq_u32 s1, 16
    s_cbranch_scc0 L_again_24
    s_branch L_ok_22
L_again_26:
    buffer_load_dwordx4 v[240:243], v239, s[48:51], s4 offen offset:0 sc1
    buffer_load_dwordx4 v[244:247], v239, s[48:51], s4 offen offset:1024 sc1
    s_sub_u32 s3, s3, 1
    s_cbranch_scc1 L_end
    s_waitcnt vmcnt(0)
    v_max_u32 v13, v240, v241
    v_max3_u32 v13, v13, v242, v243
    v_max3_u32 v13, v13, v244, v245
    v_max3_u32 v13, v13, v246, v247
    v_cmp_eq_u32 vcc, -1, v13
    s_nop 0
    s_cbranch_vccnz L_again_26
    s_branch L_ok_25
L_slow_28:
    s_waitcnt lgkmcnt(0)
    s_cmp_eq_u32 s1, 16
    s_cbranch_scc1 L_ok_27
L_again_29:
    s_mov_b32 s1, 0
    s_atomic_add s1, s[22:23], s61 offset:32768 glc
    s_sub_u32 s3, s3, 1
    s_cbranch_scc1 L_end
    s_waitcnt lgkmcnt(0)
    s_cmp_eq_u32 s1, 16
    s_cbranch_scc0 L_again_29
    s_branch L_ok_27
L_slow_31:
    s_waitcnt lgkmcnt(0)
    s_cmp_eq_u32 s1, 8
    s_cbranch_scc1 L_ok_30
L_again_32:
    s_mov_b32 s1, 0
    s_atomic_add s1, s[22:23], s61 offset:49152 glc
    s_sub_u32 s3, s3, 1
    s_cbranch_scc1 L_end
    s_waitcnt lgkmcnt(0)
    s_cmp_eq_u32 s1, 8
    s_cbranch_scc0 L_again_32
    s_branch L_ok_30
L_slow_34:
    s_waitcnt lgkmcnt(0)
    s_cmp_eq_u32 s1, 8
    s_cbranch_scc1 L_ok_33
L_again_35:
    s_mov_b32 s1, 0
    s_atomic_add s1, s[22:23], s61 offset:65536 glc
    s_sub_u32 s3, s3, 1
    s_cbranch_scc1 L_end
    s_waitcnt lgkmcnt(0)
    s_cmp_eq_u32 s1, 8
    s_cbranch_scc0 L_again_35
    s_branch L_ok_33
L_slow_37:
    s_waitcnt lgkmcnt(0)
    s_cmp_eq_u32 s1, 8
    s_cbranch_scc1 L_ok_36
L_again_38:
    s_mov_b32 s1, 0
    s_atomic_add s1, s[22:23], s61 offset:81920 glc
    s_sub_u32 s3, s3, 1
    s_cbranch_scc1 L_end
    s_waitcnt lgkmcnt(0)
    s_cmp_eq_u32 s1, 8
    s_cbranch_scc0 L_again_38
    s_branch L_ok_36
L_end:
    s_endpgm
L_pad7:
    s_branch L_back
.section .rodata,"a"
.p2align 6
.amdhsa_kernel sequential_preLN__linear_attn_block__swiglu_ffn__prompt_kernel
  .amdhsa_next_free_vgpr 512
  .amdhsa_next_free_sgpr 102
  .amdhsa_accum_offset 256
  .amdhsa_group_segment_fixed_size 0
  .amdhsa_kernarg_size 80
  .amdhsa_user_sgpr_count 2
  .amdhsa_user_sgpr_kernarg_segment_ptr 1
  .amdhsa_system_sgpr_workgroup_id_x 1
.end_amdhsa_kernel
```
